```python
import torch

def _softmax(x, axis=-1):
    return torch.softmax(x, dim=axis)
def _gelu(x):
    return torch.nn.functional.gelu(x, approximate="tanh")
def _silu(x):
    return torch.nn.functional.silu(x)
def _sigmoid(x):
    return torch.sigmoid(x)
def _layernorm(x, axis=-1, eps=1e-5):
    m = x.mean(dim=axis, keepdim=True)
    v = x.var(dim=axis, keepdim=True, unbiased=False)
    return (x - m) / torch.sqrt(v + eps)
def _scatter_add(tgt, idx, src, axis=0):
    return tgt.clone().index_add_(axis, idx, src)
def _segment_sum(src, seg, n):
    out = torch.zeros((n,) + src.shape[1:], dtype=src.dtype)
    return out.index_add_(0, seg, src)
def _pad(x, pw):
    flat = tuple(v for pair in reversed(pw) for v in pair)
    return torch.nn.functional.pad(x, flat)

kernel_name = 'gated_mix__ssm_conv_s4d__moe_arch_mod__prompt'

def setup_inputs():

    _w = (lambda a: (lambda t: t.to(torch.bfloat16) if t.is_floating_point() else t)(torch.as_tensor(a)))
    def _A_setup():
        Bsz, L, D, N = 1, 2048, 1024, 128
        return {
            "u": _w((lambda *s: torch.randn(*s, dtype=torch.bfloat16) * 0.05)(Bsz, L, D)),
            "log_A_real": _w((lambda *s: torch.randn(*s, dtype=torch.bfloat16) * 6.4)(D, N) * 0.5),
            "A_imag": _w((lambda *s: torch.randn(*s, dtype=torch.bfloat16) * 0.1)(D, N) * 3.14),
            "C_real": _w((lambda *s: torch.randn(*s, dtype=torch.bfloat16) * 0.4)(D, N) / N ** 0.5),
            "C_imag": _w((lambda *s: torch.randn(*s, dtype=torch.bfloat16) * 0.4)(D, N) / N ** 0.5),
            "log_dt": _w((lambda *s: torch.randn(*s, dtype=torch.bfloat16) * 0.1)(D) * 0.5 - 4.0),
            "D_skip": _w((lambda *s: torch.randn(*s, dtype=torch.bfloat16) * 0.1)(D)),
        }
    _A_in = _A_setup()

    def _B_setup():
        B, S, D, F, C = 1, 2048, 1024, 3584, 8
        return {
            "x": _w((lambda *s: torch.randn(*s, dtype=torch.bfloat16) * 0.05)(B, S, D)),
            "w_r": _w((lambda *s: torch.randn(*s, dtype=torch.bfloat16) * 6.4)(D)),
            "w_gate": _w((lambda *s: torch.randn(*s, dtype=torch.bfloat16) * 0.1)(D, F)),
            "w_up": _w((lambda *s: torch.randn(*s, dtype=torch.bfloat16) * 0.1)(D, F)),
            "w_down": _w((lambda *s: torch.randn(*s, dtype=torch.bfloat16) * 0.1)(F, D)),
        }
    _B_in = _B_setup()

    return {
        "A_u": _A_in["u"],
        "A_log_A_real": _A_in["log_A_real"],
        "A_A_imag": _A_in["A_imag"],
        "A_C_real": _A_in["C_real"],
        "A_C_imag": _A_in["C_imag"],
        "A_log_dt": _A_in["log_dt"],
        "A_D_skip": _A_in["D_skip"],
        "B_x": _B_in["x"],
        "B_w_r": _B_in["w_r"],
        "B_w_gate": _B_in["w_gate"],
        "B_w_up": _B_in["w_up"],
        "B_w_down": _B_in["w_down"],
        "gate_w": _w((lambda *s: torch.randn(*s, dtype=torch.bfloat16) * 0.05)(1024) * 16.0),
    }

def reference(A_u, A_log_A_real, A_A_imag, A_C_real, A_C_imag, A_log_dt, A_D_skip, B_x, B_w_r, B_w_gate, B_w_up, B_w_down, gate_w):
    def _A_ref(u, log_A_real, A_imag, C_real, C_imag, log_dt, D_skip):
        L = u.shape[1]
        dt = torch.exp(log_dt)
        A = -torch.exp(log_A_real) + 1j * A_imag
        C = (C_real + 1j * C_imag) * dt[:, None]
        pos = (lambda x, dt: x.to(dt))(torch.arange(L), log_dt.dtype)
        P = torch.exp((A * dt[:, None])[:, :, None] * pos[None, None, :])
        K = 2.0 * torch.einsum("dn,dnl->dl", C, P).real
        L2 = 2 * L
        u_t = (lambda x, *d: x.permute(*d))(u, 0, 2, 1)
        Kf = (lambda x, *a, **k: torch.fft.rfft(x.float(), *a, **k))(K, L2)
        Uf = (lambda x, *a, **k: torch.fft.rfft(x.float(), *a, **k))(u_t, L2)
        y = (lambda x, *a, **k: torch.fft.irfft(x, *a, **k).to(torch.bfloat16))(Uf * Kf[None, :, :], L2)[:, :, :L]
        y = (lambda x, *d: x.permute(*d))(y, 0, 2, 1)
        return y + u * D_skip[None, None, :]

    def _B_ref(x, w_r, w_gate, w_up, w_down):
        B, S, D = x.shape
        C = 8
        r = x @ w_r
        idx = torch.argsort(-r, axis=-1)[:, :C]
        idx_e = (lambda x, n, axis: torch.repeat_interleave(x, n, dim=axis))(idx.reshape(B, C, 1), D, axis=2)
        x_sel = (lambda x, i, axis: torch.take_along_dim(x, i, dim=axis))(x, idx_e, axis=1)
        g = _silu(x_sel @ w_gate)
        u = x_sel @ w_up
        y = (g * u) @ w_down
        r_sel = _sigmoid((lambda x, i, axis: torch.take_along_dim(x, i, dim=axis))(r, idx, axis=1))
        y = y * r_sel.reshape(B, C, 1)
        b_off = (torch.arange(B) * S).reshape(B, 1)
        flat_idx = (idx + b_off).reshape(B * C)
        zero = (x * 0.0).reshape(B * S, D)
        upd = _scatter_add(zero, flat_idx, y.reshape(B * C, D), axis=0)
        return x + upd.reshape(B, S, D)

    x = A_u
    g = _sigmoid((x * gate_w).sum(-1, keepdims=True))
    a = _A_ref(x, A_log_A_real, A_A_imag, A_C_real, A_C_imag, A_log_dt, A_D_skip)
    b = _B_ref(x, B_w_r, B_w_gate, B_w_up, B_w_down)
    return g * a + (1 - g) * b
```

```asm
; @launch grid=(256,1,1) block=(512,1,1) lds=162304
.amdgcn_target "amdgcn-amd-amdhsa--gfx950"
.text
.globl gated_mix__ssm_conv_s4d__moe_arch_mod__prompt_kernel
.p2align 8
.type gated_mix__ssm_conv_s4d__moe_arch_mod__prompt_kernel,@function
gated_mix__ssm_conv_s4d__moe_arch_mod__prompt_kernel:
    s_cmp_ge_u32 s2, 256
    s_cbranch_scc1 L_end
    s_load_dwordx16 s[16:31], s[0:1], 0
    s_load_dwordx16 s[32:47], s[0:1], 64
    v_lshrrev_b32 v2, 6, v0
    v_and_b32 v1, 63, v0
    v_readfirstlane_b32 s3, v2
    s_cmp_lg_u32 s3, 7
    s_cbranch_scc1 L_nocpre
    s_getpc_b64 s[4:5]
L_pc:
    s_bfe_u32 s6, s2, 0x20003
    s_lshl_b32 s6, s6, 13
    v_lshl_add_u32 v3, v1, 7, s6
    v_min_u32 v3, L_codeend-L_pc-4, v3
    global_load_dword v63, v3, s[4:5]
L_nocpre:
    s_and_b32 s4, s2, 7
    s_bfe_u32 s5, s2, 0x40003
    s_xor_b32 s101, s4, 4
    v_lshlrev_b32 v3, 4, v1
    s_cmp_ge_u32 s2, 128
    s_cbranch_scc1 L_conv
    s_lshl_b32 s6, s2, 3
    s_add_u32 s6, s6, s3
    s_lshl_b32 s6, s6, 12
    v_add_u32 v4, s6, v3
    s_and_b32 s6, s3, 3
    s_lshl_b32 s6, s6, 9
    v_add_u32 v2, s6, v3
    s_lshl_b32 s6, s3, 9
    s_add_u32 m0, s6, 16384
    s_bitcmp1_b32 s3, 2
    s_waitcnt lgkmcnt(0)
    s_cselect_b64 s[14:15], s[40:41], s[32:33]
    s_mov_b32 exec_hi, 0
    global_load_lds_dwordx4 v2, s[14:15]
    s_mov_b32 exec_hi, -1
    global_load_dwordx4 v[128:131], v4, s[16:17] offset:0
    global_load_dwordx4 v[132:135], v4, s[16:17] offset:1024
    global_load_dwordx4 v[136:139], v4, s[16:17] offset:2048
    global_load_dwordx4 v[140:143], v4, s[16:17] offset:3072
    s_branch L_moe
L_conv:
    s_lshl_b32 s6, s4, 2
    s_lshr_b32 s6, 0x75643210, s6
    s_and_b32 s59, s6, 7
    s_lshl_b32 s6, s59, 4
    s_add_u32 s63, s6, s5
    s_lshl_b32 s6, s63, 3
    s_add_u32 s6, s6, s3
    s_lshl_b32 s7, s6, 8
    v_lshl_add_u32 v5, v1, 2, s7
    s_lshl_b32 s10, s6, 1
    s_and_b32 s10, s10, 0x7fc
    s_mul_i32 s61, s3, 19008
    s_mov_b32 m0, s61
    s_waitcnt lgkmcnt(0)
    global_load_dword v196, v5, s[18:19]
    global_load_dword v197, v5, s[20:21]
    s_load_dword s66, s[26:27], s10
    s_load_dword s67, s[28:29], s10
    v_and_b32 v59, 15, v1
    v_lshrrev_b32 v7, 4, v1
    v_lshl_add_u32 v56, v7, 3, v59
    v_min_u32 v56, 31, v56
    s_lshl_b32 s9, s3, 2
    s_lshr_b32 s6, 0x23452, s9
    s_lshr_b32 s7, 0x29753, s9
    s_and_b32 s6, s6, 15
    s_and_b32 s7, s7, 15
    s_add_u32 s6, s6, 16
    s_bfm_b32 s6, s7, s6
    s_cmp_eq_u32 s3, 4
    s_movk_i32 s7, 0x3f80
    v_mov_b32 v58, s7
    s_cselect_b32 s7, 0xffff, s7
    v_bfe_u32 v57, s6, v56, 8
    v_lshl_or_b32 v57, v57, 15, v57
    v_and_b32 v12, 0x10001, v57
    v_mul_u32_u24 v12, s7, v12
    v_lshrrev_b32 v13, 2, v57
    v_and_b32 v13, 0x10001, v13
    v_mul_u32_u24 v13, s7, v13
    v_lshrrev_b32 v14, 4, v57
    v_and_b32 v14, 0x10001, v14
    v_mul_u32_u24 v14, s7, v14
    v_lshrrev_b32 v15, 6, v57
    v_and_b32 v15, 0x10001, v15
    v_mul_u32_u24 v15, s7, v15
    v_add_u32 v4, 152064, v3
    s_lshl_b32 s6, s3, 10
    v_add_u32 v57, s6, v4
    v_lshlrev_b32 v2, 2, v0
    v_add_u32 v2, 160256, v2
    v_mov_b32 v54, 0
    ds_write_b128 v57, v[12:15]
    ds_write_b32 v2, v58
    global_load_dword v198, v5, s[22:23]
    global_load_dword v199, v5, s[24:25]
    ds_write_addtid_b32 v54 offset:18416
    ds_write_addtid_b32 v54 offset:18672
    s_lshl_b32 s60, s63, 4
    s_and_b32 s11, s3, 1
    s_lshl_b32 s11, s11, 4
    v_lshlrev_b32 v48, 12, v0
    v_sub_u32 v48, 2093056, v48
    v_lshlrev_b32 v11, 11, v0
    s_lshl_b32 s6, s5, 3
    s_add_u32 s6, s6, s3
    s_lshl_b32 s6, s6, 15
    s_lshl_b32 s9, s59, 8
    s_add_u32 s6, s6, s9
    v_lshrrev_b32 v2, 1, v1
    v_lshl_add_u32 v2, v2, 11, s6
    v_and_b32 v3, 1, v1
    v_lshl_add_u32 v245, v3, 7, v2
    s_mov_b32 s48, s16
    s_mov_b32 s49, s17
    s_mov_b32 s50, 4194304
    s_mov_b32 s51, 0x00020000
    s_lshl_b32 s6, s5, 3
    s_lshr_b32 s7, s3, 1
    s_add_u32 s6, s6, s7
    s_add_u32 s6, s6, 4
    s_mul_i32 s6, s6, 57344
    s_lshr_b32 s7, s34, 7
    s_sub_u32 s7, s101, s7
    s_add_u32 s7, s7, 3
    s_and_b32 s7, s7, 7
    s_min_u32 s7, s7, 6
    s_mul_i32 s9, s101, 7
    s_add_u32 s7, s7, s9
    s_lshl_b32 s7, s7, 7
    s_add_u32 s6, s6, s7
    v_mul_u32_u24 v0, 7168, v1
    v_add_u32 v0, s6, v0
    s_bitcmp1_b32 s3, 0
    s_cselect_b64 s[12:13], s[36:37], s[34:35]
    s_mov_b64 s[70:71], 0xff
    s_mov_b64 exec, s[70:71]
    global_load_dword v10, v0, s[12:13]
    s_mov_b64 exec, -1
    v_and_b32 v56, 31, v1
    v_lshrrev_b32 v57, 5, v1
    v_mul_u32_u24 v49, 528, v56
    v_lshl_add_u32 v58, v57, 4, s61
    v_add_u32 v49, v49, v58
    v_subrev_u32 v53, 528, v49
    v_cmp_eq_u32 vcc, 0, v56
    v_and_b32 v58, 0xff, v53
    v_add_u32 v58, 160256, v58
    v_cndmask_b32 v53, v53, v58, vcc
    s_waitcnt lgkmcnt(0)
    s_barrier
    s_lshr_b32 s66, s66, s11
    s_lshr_b32 s67, s67, s11
    s_lshl_b32 s66, s66, 16
    s_lshl_b32 s67, s67, 16
    v_mov_b32 v200, 0x3fb8aa3b
    v_mul_f32 v200, s66, v200
    v_exp_f32 v200, v200
    v_mov_b32 v55, 0
    v_cvt_pk_bf16_f32 v200, v200, v200
    v_writelane_b32 v55, s67, 0
    v_lshlrev_b32 v200, 16, v200
    v_mul_f32 v202, 0xbfb8aa3b, v200
    v_mul_f32 v203, 0x3e22f983, v200
    v_add_f32 v200, v200, v200
    s_waitcnt vmcnt(3)
    v_lshlrev_b32 v204, 16, v196
    v_and_b32 v206, 0xffff0000, v196
    v_mul_f32 v204, 0x3fb8aa3b, v204
    v_mul_f32 v206, 0x3fb8aa3b, v206
    v_exp_f32 v204, v204
    v_exp_f32 v206, v206
    v_lshlrev_b32 v205, 16, v197
    v_cvt_pk_bf16_f32 v206, v204, v206
    v_and_b32 v207, 0xffff0000, v197
    v_lshlrev_b32 v204, 16, v206
    v_and_b32 v206, 0xffff0000, v206
    v_pk_mul_f32 v[204:205], v[204:205], v[202:203]
    v_pk_mul_f32 v[206:207], v[206:207], v[202:203]
    v_mul_f32 v208, 0x41000000, v204
    v_mul_f32 v209, 0x41000000, v205
    v_mul_f32 v210, 0x41000000, v206
    v_mul_f32 v211, 0x41000000, v207
    v_fract_f32 v209, v209
    v_fract_f32 v211, v211
    v_exp_f32 v208, v208
    v_cos_f32 v136, v209
    v_sin_f32 v137, v209
    v_exp_f32 v210, v210
    v_cos_f32 v138, v211
    v_sin_f32 v139, v211
    v_pk_mul_f32 v[136:137], v[136:137], v[208:209] op_sel:[0,0] op_sel_hi:[1,0]
    v_pk_mul_f32 v[138:139], v[138:139], v[210:211] op_sel:[0,0] op_sel_hi:[1,0]
.p2align 3
    v_pk_mul_f32 v[148:149], v[136:137], v[136:137] op_sel:[0,0] op_sel_hi:[0,1]
    v_pk_mul_f32 v[150:151], v[138:139], v[138:139] op_sel:[0,0] op_sel_hi:[0,1]
    v_cvt_pk_bf16_f32 v152, v136, v137
    v_pk_fma_f32 v[160:161], v[136:137], v[136:137], v[148:149] op_sel:[1,1,0] op_sel_hi:[1,0,1] neg_lo:[0,1,0]
    v_pk_fma_f32 v[162:163], v[138:139], v[138:139], v[150:151] op_sel:[1,1,0] op_sel_hi:[1,0,1] neg_lo:[0,1,0]
    v_cvt_pk_bf16_f32 v153, v138, v139
    v_pk_mul_f32 v[148:149], v[160:161], v[136:137] op_sel:[0,0] op_sel_hi:[0,1]
    v_pk_mul_f32 v[150:151], v[162:163], v[138:139] op_sel:[0,0] op_sel_hi:[0,1]
    s_mov_b32 s52, s42
    s_mov_b32 s53, s43
    ds_write_addtid_b32 v152 offset:0
    v_cvt_pk_bf16_f32 v154, v160, v161
    v_pk_fma_f32 v[164:165], v[160:161], v[136:137], v[148:149] op_sel:[1,1,0] op_sel_hi:[1,0,1] neg_lo:[0,1,0]
    v_pk_fma_f32 v[166:167], v[162:163], v[138:139], v[150:151] op_sel:[1,1,0] op_sel_hi:[1,0,1] neg_lo:[0,1,0]
    s_mov_b32 s54, 4194304
    ds_write_addtid_b32 v153 offset:256
    v_cvt_pk_bf16_f32 v155, v162, v163
    v_pk_mul_f32 v[148:149], v[164:165], v[136:137] op_sel:[0,0] op_sel_hi:[0,1]
    v_pk_mul_f32 v[150:151], v[166:167], v[138:139] op_sel:[0,0] op_sel_hi:[0,1]
    s_mov_b32 s55, 0x00020000
    ds_write_addtid_b32 v154 offset:528
    v_cvt_pk_bf16_f32 v156, v164, v165
    v_pk_fma_f32 v[160:161], v[164:165], v[136:137], v[148:149] op_sel:[1,1,0] op_sel_hi:[1,0,1] neg_lo:[0,1,0]
    v_pk_fma_f32 v[162:163], v[166:167], v[138:139], v[150:151] op_sel:[1,1,0] op_sel_hi:[1,0,1] neg_lo:[0,1,0]
    s_add_u32 s8, s60, 2097152
    ds_write_addtid_b32 v155 offset:784
    v_cvt_pk_bf16_f32 v157, v166, v167
    v_pk_mul_f32 v[148:149], v[160:161], v[136:137] op_sel:[0,0] op_sel_hi:[0,1]
    v_pk_mul_f32 v[150:151], v[162:163], v[138:139] op_sel:[0,0] op_sel_hi:[0,1]
    s_mov_b32 s14, 0xaaaaaaaa
    ds_write_addtid_b32 v156 offset:1056
    v_cvt_pk_bf16_f32 v152, v160, v161
    v_pk_fma_f32 v[164:165], v[160:161], v[136:137], v[148:149] op_sel:[1,1,0] op_sel_hi:[1,0,1] neg_lo:[0,1,0]
    v_pk_fma_f32 v[166:167], v[162:163], v[138:139], v[150:151] op_sel:[1,1,0] op_sel_hi:[1,0,1] neg_lo:[0,1,0]
    s_mov_b32 s15, 0xaaaaaaaa
    ds_write_addtid_b32 v157 offset:1312
    v_cvt_pk_bf16_f32 v153, v162, v163
    v_pk_mul_f32 v[148:149], v[164:165], v[136:137] op_sel:[0,0] op_sel_hi:[0,1]
    v_pk_mul_f32 v[150:151], v[166:167], v[138:139] op_sel:[0,0] op_sel_hi:[0,1]
    s_mov_b32 s64, 0x05040100
    ds_write_addtid_b32 v152 offset:1584
    v_cvt_pk_bf16_f32 v154, v164, v165
    v_pk_fma_f32 v[160:161], v[164:165], v[136:137], v[148:149] op_sel:[1,1,0] op_sel_hi:[1,0,1] neg_lo:[0,1,0]
    v_pk_fma_f32 v[162:163], v[166:167], v[138:139], v[150:151] op_sel:[1,1,0] op_sel_hi:[1,0,1] neg_lo:[0,1,0]
    s_mov_b32 s65, 0x07060302
    ds_write_addtid_b32 v153 offset:1840
    v_cvt_pk_bf16_f32 v155, v166, v167
    v_pk_mul_f32 v[148:149], v[160:161], v[136:137] op_sel:[0,0] op_sel_hi:[0,1]
    v_pk_mul_f32 v[150:151], v[162:163], v[138:139] op_sel:[0,0] op_sel_hi:[0,1]
    s_lshl_b32 s68, s3, 8
    s_nop 0
    ds_write_addtid_b32 v154 offset:2112
    v_cvt_pk_bf16_f32 v156, v160, v161
    v_pk_fma_f32 v[164:165], v[160:161], v[136:137], v[148:149] op_sel:[1,1,0] op_sel_hi:[1,0,1] neg_lo:[0,1,0]
    v_pk_fma_f32 v[166:167], v[162:163], v[138:139], v[150:151] op_sel:[1,1,0] op_sel_hi:[1,0,1] neg_lo:[0,1,0]
    s_add_u32 s68, s68, 14320
    ds_write_addtid_b32 v155 offset:2368
    v_cvt_pk_bf16_f32 v157, v162, v163
    v_pk_mul_f32 v[148:149], v[164:165], v[136:137] op_sel:[0,0] op_sel_hi:[0,1]
    v_pk_mul_f32 v[150:151], v[166:167], v[138:139] op_sel:[0,0] op_sel_hi:[0,1]
    s_add_u32 s69, s68, 76032
    ds_write_addtid_b32 v156 offset:2640
    v_cvt_pk_bf16_f32 v152, v164, v165
    v_pk_fma_f32 v[160:161], v[164:165], v[136:137], v[148:149] op_sel:[1,1,0] op_sel_hi:[1,0,1] neg_lo:[0,1,0]
    v_pk_fma_f32 v[162:163], v[166:167], v[138:139], v[150:151] op_sel:[1,1,0] op_sel_hi:[1,0,1] neg_lo:[0,1,0]
    s_mov_b32 s10, 0
    s_nop 0
    ds_write_addtid_b32 v157 offset:2896
    v_cvt_pk_bf16_f32 v153, v166, v167
    v_pk_mul_f32 v[148:149], v[160:161], v[136:137] op_sel:[0,0] op_sel_hi:[0,1]
    v_pk_mul_f32 v[150:151], v[162:163], v[138:139] op_sel:[0,0] op_sel_hi:[0,1]
    s_add_u32 s6, s61, 14800
    ds_write_addtid_b32 v152 offset:3168
    ds_read_b128 v[12:15], v4 offset:0
    v_cvt_pk_bf16_f32 v154, v160, v161
    v_pk_fma_f32 v[164:165], v[160:161], v[136:137], v[148:149] op_sel:[1,1,0] op_sel_hi:[1,0,1] neg_lo:[0,1,0]
    v_pk_fma_f32 v[166:167], v[162:163], v[138:139], v[150:151] op_sel:[1,1,0] op_sel_hi:[1,0,1] neg_lo:[0,1,0]
    s_mov_b32 s18, s6
    s_nop 0
    ds_write_addtid_b32 v153 offset:3424
    v_cvt_pk_bf16_f32 v155, v162, v163
    v_pk_mul_f32 v[148:149], v[164:165], v[136:137] op_sel:[0,0] op_sel_hi:[0,1]
    v_pk_mul_f32 v[150:151], v[166:167], v[138:139] op_sel:[0,0] op_sel_hi:[0,1]
    s_add_u32 s6, s61, 6960
    ds_write_addtid_b32 v154 offset:3696
    v_cvt_pk_bf16_f32 v156, v164, v165
    v_pk_fma_f32 v[160:161], v[164:165], v[136:137], v[148:149] op_sel:[1,1,0] op_sel_hi:[1,0,1] neg_lo:[0,1,0]
    v_pk_fma_f32 v[162:163], v[166:167], v[138:139], v[150:151] op_sel:[1,1,0] op_sel_hi:[1,0,1] neg_lo:[0,1,0]
    s_mov_b32 s19, s6
    s_lshl_b32 s6, s3, 11
    ds_write_addtid_b32 v155 offset:3952
    v_cvt_pk_bf16_f32 v157, v166, v167
    v_pk_mul_f32 v[148:149], v[160:161], v[136:137] op_sel:[0,0] op_sel_hi:[0,1]
    v_pk_mul_f32 v[150:151], v[162:163], v[138:139] op_sel:[0,0] op_sel_hi:[0,1]
    s_add_u32 s6, s6, 65536
    ds_write_addtid_b32 v156 offset:4224
    v_cvt_pk_bf16_f32 v152, v160, v161
    v_pk_fma_f32 v[164:165], v[160:161], v[136:137], v[148:149] op_sel:[1,1,0] op_sel_hi:[1,0,1] neg_lo:[0,1,0]
    v_pk_fma_f32 v[166:167], v[162:163], v[138:139], v[150:151] op_sel:[1,1,0] op_sel_hi:[1,0,1] neg_lo:[0,1,0]
    s_mov_b32 s20, s6
    s_lshr_b32 s6, s3, 2
    ds_write_addtid_b32 v157 offset:4480
    v_cvt_pk_bf16_f32 v153, v162, v163
    v_pk_mul_f32 v[148:149], v[164:165], v[136:137] op_sel:[0,0] op_sel_hi:[0,1]
    v_pk_mul_f32 v[150:151], v[166:167], v[138:139] op_sel:[0,0] op_sel_hi:[0,1]
    s_mul_i32 s6, s6, 448
    ds_write_addtid_b32 v152 offset:4752
    ds_read_b128 v[16:19], v4 offset:1024
    v_cvt_pk_bf16_f32 v154, v164, v165
    v_pk_fma_f32 v[160:161], v[164:165], v[136:137], v[148:149] op_sel:[1,1,0] op_sel_hi:[1,0,1] neg_lo:[0,1,0]
    v_pk_fma_f32 v[162:163], v[166:167], v[138:139], v[150:151] op_sel:[1,1,0] op_sel_hi:[1,0,1] neg_lo:[0,1,0]
    s_lshl_b32 s7, s3, 5
    s_add_u32 s6, s6, s7
    ds_write_addtid_b32 v153 offset:5008
    v_cvt_pk_bf16_f32 v155, v166, v167
    v_pk_mul_f32 v[148:149], v[160:161], v[136:137] op_sel:[0,0] op_sel_hi:[0,1]
    v_pk_mul_f32 v[150:151], v[162:163], v[138:139] op_sel:[0,0] op_sel_hi:[0,1]
    s_mov_b32 s21, s6
    s_lshl_b32 s6, s3, 10
    ds_write_addtid_b32 v154 offset:5280
    s_mov_b32 exec_hi, 0
    buffer_load_dword v10, v245, s[48:51], 0 offen
    s_mov_b32 exec_hi, -1
    v_cvt_pk_bf16_f32 v156, v160, v161
    v_pk_fma_f32 v[164:165], v[160:161], v[136:137], v[148:149] op_sel:[1,1,0] op_sel_hi:[1,0,1] neg_lo:[0,1,0]
    v_pk_fma_f32 v[166:167], v[162:163], v[138:139], v[150:151] op_sel:[1,1,0] op_sel_hi:[1,0,1] neg_lo:[0,1,0]
    s_add_u32 s6, s6, 152064
    ds_write_addtid_b32 v155 offset:5536
    v_cvt_pk_bf16_f32 v157, v162, v163
    v_pk_mul_f32 v[148:149], v[164:165], v[136:137] op_sel:[0,0] op_sel_hi:[0,1]
    v_pk_mul_f32 v[150:151], v[166:167], v[138:139] op_sel:[0,0] op_sel_hi:[0,1]
    s_mov_b32 s22, s6
    s_mul_i32 s6, s5, 7
    ds_write_addtid_b32 v156 offset:5808
    v_cvt_pk_bf16_f32 v152, v164, v165
    v_pk_fma_f32 v[160:161], v[164:165], v[136:137], v[148:149] op_sel:[1,1,0] op_sel_hi:[1,0,1] neg_lo:[0,1,0]
    v_pk_fma_f32 v[162:163], v[166:167], v[138:139], v[150:151] op_sel:[1,1,0] op_sel_hi:[1,0,1] neg_lo:[0,1,0]
    s_min_u32 s7, s3, 6
    s_add_u32 s6, s6, s7
    ds_write_addtid_b32 v157 offset:6064
    v_cvt_pk_bf16_f32 v153, v166, v167
    v_pk_mul_f32 v[148:149], v[160:161], v[136:137] op_sel:[0,0] op_sel_hi:[0,1]
    v_pk_mul_f32 v[150:151], v[162:163], v[138:139] op_sel:[0,0] op_sel_hi:[0,1]
    s_lshl_b32 s7, s6, 1
    s_and_b32 s27, s59, 3
    ds_write_addtid_b32 v152 offset:6336
    ds_read_b128 v[20:23], v4 offset:2048
    v_cvt_pk_bf16_f32 v154, v160, v161
    v_pk_fma_f32 v[164:165], v[160:161], v[136:137], v[148:149] op_sel:[1,1,0] op_sel_hi:[1,0,1] neg_lo:[0,1,0]
    v_pk_fma_f32 v[166:167], v[162:163], v[138:139], v[150:151] op_sel:[1,1,0] op_sel_hi:[1,0,1] neg_lo:[0,1,0]
    s_cmp_eq_u32 s27, 1
    s_cselect_b32 s6, s7, s6
    ds_write_addtid_b32 v153 offset:6592
    v_cvt_pk_bf16_f32 v155, v162, v163
    v_pk_mul_f32 v[148:149], v[164:165], v[136:137] op_sel:[0,0] op_sel_hi:[0,1]
    v_pk_mul_f32 v[150:151], v[166:167], v[138:139] op_sel:[0,0] op_sel_hi:[0,1]
    s_cselect_b32 s71, -1, 0
    s_nop 0
    ds_write_addtid_b32 v154 offset:6864
    v_cvt_pk_bf16_f32 v156, v164, v165
    v_pk_fma_f32 v[160:161], v[164:165], v[136:137], v[148:149] op_sel:[1,1,0] op_sel_hi:[1,0,1] neg_lo:[0,1,0]
    v_pk_fma_f32 v[162:163], v[166:167], v[138:139], v[150:151] op_sel:[1,1,0] op_sel_hi:[1,0,1] neg_lo:[0,1,0]
    s_cmp_lt_u32 s6, 112
    ds_write_addtid_b32 v155 offset:7120
    v_cvt_pk_bf16_f32 v157, v166, v167
    v_pk_mul_f32 v[148:149], v[160:161], v[136:137] op_sel:[0,0] op_sel_hi:[0,1]
    v_pk_mul_f32 v[150:151], v[162:163], v[138:139] op_sel:[0,0] op_sel_hi:[0,1]
    s_cselect_b32 s70, -1, 1
    s_cselect_b32 s71, s71, 0
    ds_write_addtid_b32 v156 offset:7392
    v_cvt_pk_bf16_f32 v152, v160, v161
    v_pk_fma_f32 v[164:165], v[160:161], v[136:137], v[148:149] op_sel:[1,1,0] op_sel_hi:[1,0,1] neg_lo:[0,1,0]
    v_pk_fma_f32 v[166:167], v[162:163], v[138:139], v[150:151] op_sel:[1,1,0] op_sel_hi:[1,0,1] neg_lo:[0,1,0]
    s_min_u32 s6, s6, 111
    ds_write_addtid_b32 v157 offset:7648
    v_cvt_pk_bf16_f32 v153, v162, v163
    v_pk_mul_f32 v[148:149], v[164:165], v[136:137] op_sel:[0,0] op_sel_hi:[0,1]
    v_pk_mul_f32 v[150:151], v[166:167], v[138:139] op_sel:[0,0] op_sel_hi:[0,1]
    s_and_b32 s7, s6, 0x70
    ds_write_addtid_b32 v152 offset:7920
    ds_read_b128 v[24:27], v4 offset:3072
    v_cvt_pk_bf16_f32 v154, v164, v165
    v_pk_fma_f32 v[160:161], v[164:165], v[136:137], v[148:149] op_sel:[1,1,0] op_sel_hi:[1,0,1] neg_lo:[0,1,0]
    v_pk_fma_f32 v[162:163], v[166:167], v[138:139], v[150:151] op_sel:[1,1,0] op_sel_hi:[1,0,1] neg_lo:[0,1,0]
    s_add_u32 s6, s6, s7
    s_nop 0
    ds_write_addtid_b32 v153 offset:8176
    v_cvt_pk_bf16_f32 v155, v166, v167
    v_pk_mul_f32 v[148:149], v[160:161], v[136:137] op_sel:[0,0] op_sel_hi:[0,1]
    v_pk_mul_f32 v[150:151], v[162:163], v[138:139] op_sel:[0,0] op_sel_hi:[0,1]
    s_mul_i32 s7, s101, 224
    ds_write_addtid_b32 v154 offset:8448
    buffer_load_dwordx4 v[232:235], v48, s[48:51], s60 offen offset:0
    v_cvt_pk_bf16_f32 v156, v160, v161
    v_pk_fma_f32 v[164:165], v[160:161], v[136:137], v[148:149] op_sel:[1,1,0] op_sel_hi:[1,0,1] neg_lo:[0,1,0]
    v_pk_fma_f32 v[166:167], v[162:163], v[138:139], v[150:151] op_sel:[1,1,0] op_sel_hi:[1,0,1] neg_lo:[0,1,0]
    s_add_u32 s6, s6, s7
    s_lshl_b32 s6, s6, 12
    ds_write_addtid_b32 v155 offset:8704
    v_cvt_pk_bf16_f32 v157, v162, v163
    v_pk_mul_f32 v[148:149], v[164:165], v[136:137] op_sel:[0,0] op_sel_hi:[0,1]
    v_pk_mul_f32 v[150:151], v[166:167], v[138:139] op_sel:[0,0] op_sel_hi:[0,1]
    s_add_u32 s6, s6, 65536
    ds_write_addtid_b32 v156 offset:8976
    v_cvt_pk_bf16_f32 v152, v164, v165
    v_pk_fma_f32 v[160:161], v[164:165], v[136:137], v[148:149] op_sel:[1,1,0] op_sel_hi:[1,0,1] neg_lo:[0,1,0]
    v_pk_fma_f32 v[162:163], v[166:167], v[138:139], v[150:151] op_sel:[1,1,0] op_sel_hi:[1,0,1] neg_lo:[0,1,0]
    s_mov_b32 s23, s6
    s_lshl_b32 s6, s63, 3
    ds_write_addtid_b32 v157 offset:9232
    v_cvt_pk_bf16_f32 v153, v166, v167
    v_pk_mul_f32 v[148:149], v[160:161], v[136:137] op_sel:[0,0] op_sel_hi:[0,1]
    v_pk_mul_f32 v[150:151], v[162:163], v[138:139] op_sel:[0,0] op_sel_hi:[0,1]
    s_add_u32 s6, s6, s3
    s_lshl_b32 s6, s6, 11
    ds_write_addtid_b32 v152 offset:9504
    ds_read_b128 v[28:31], v4 offset:4096
    v_cvt_pk_bf16_f32 v154, v160, v161
    v_pk_fma_f32 v[164:165], v[160:161], v[136:137], v[148:149] op_sel:[1,1,0] op_sel_hi:[1,0,1] neg_lo:[0,1,0]
    v_pk_fma_f32 v[166:167], v[162:163], v[138:139], v[150:151] op_sel:[1,1,0] op_sel_hi:[1,0,1] neg_lo:[0,1,0]
    s_add_u32 s6, s6, 2097152
    ds_write_addtid_b32 v153 offset:9760
    v_cvt_pk_bf16_f32 v155, v162, v163
    v_pk_mul_f32 v[148:149], v[164:165], v[136:137] op_sel:[0,0] op_sel_hi:[0,1]
    v_pk_mul_f32 v[150:151], v[166:167], v[138:139] op_sel:[0,0] op_sel_hi:[0,1]
    s_mov_b32 s24, s6
    s_cmp_eq_u32 s3, 7
    ds_write_addtid_b32 v154 offset:10032
    v_cvt_pk_bf16_f32 v156, v164, v165
    v_pk_fma_f32 v[160:161], v[164:165], v[136:137], v[148:149] op_sel:[1,1,0] op_sel_hi:[1,0,1] neg_lo:[0,1,0]
    v_pk_fma_f32 v[162:163], v[166:167], v[138:139], v[150:151] op_sel:[1,1,0] op_sel_hi:[1,0,1] neg_lo:[0,1,0]
    s_cselect_b64 s[30:31], -1, 0
    s_mov_b32 s28, 0
    ds_write_addtid_b32 v155 offset:10288
    v_cvt_pk_bf16_f32 v157, v166, v167
    v_pk_mul_f32 v[148:149], v[160:161], v[136:137] op_sel:[0,0] op_sel_hi:[0,1]
    v_pk_mul_f32 v[150:151], v[162:163], v[138:139] op_sel:[0,0] op_sel_hi:[0,1]
    s_lshl_b32 s29, s59, 10
    s_nop 0
    ds_write_addtid_b32 v156 offset:10560
    v_cvt_pk_bf16_f32 v152, v160, v161
    v_pk_fma_f32 v[164:165], v[160:161], v[136:137], v[148:149] op_sel:[1,1,0] op_sel_hi:[1,0,1] neg_lo:[0,1,0]
    v_pk_fma_f32 v[166:167], v[162:163], v[138:139], v[150:151] op_sel:[1,1,0] op_sel_hi:[1,0,1] neg_lo:[0,1,0]
    s_add_u32 s29, s29, 180224
    ds_write_addtid_b32 v157 offset:10816
    v_cvt_pk_bf16_f32 v153, v162, v163
    v_pk_mul_f32 v[148:149], v[164:165], v[136:137] op_sel:[0,0] op_sel_hi:[0,1]
    v_pk_mul_f32 v[150:151], v[166:167], v[138:139] op_sel:[0,0] op_sel_hi:[0,1]
    s_add_u32 s9, s60, 1048576
    ds_write_addtid_b32 v152 offset:11088
    v_cvt_pk_bf16_f32 v154, v164, v165
    v_pk_fma_f32 v[160:161], v[164:165], v[136:137], v[148:149] op_sel:[1,1,0] op_sel_hi:[1,0,1] neg_lo:[0,1,0]
    v_pk_fma_f32 v[162:163], v[166:167], v[138:139], v[150:151] op_sel:[1,1,0] op_sel_hi:[1,0,1] neg_lo:[0,1,0]
    s_add_u32 s62, s60, 3145728
    ds_write_addtid_b32 v153 offset:11344
    v_cvt_pk_bf16_f32 v155, v166, v167
    v_pk_mul_f32 v[148:149], v[160:161], v[136:137] op_sel:[0,0] op_sel_hi:[0,1]
    v_pk_mul_f32 v[150:151], v[162:163], v[138:139] op_sel:[0,0] op_sel_hi:[0,1]
    ds_write_addtid_b32 v154 offset:11616
    v_cvt_pk_bf16_f32 v156, v160, v161
    v_pk_fma_f32 v[164:165], v[160:161], v[136:137], v[148:149] op_sel:[1,1,0] op_sel_hi:[1,0,1] neg_lo:[0,1,0]
    v_pk_fma_f32 v[166:167], v[162:163], v[138:139], v[150:151] op_sel:[1,1,0] op_sel_hi:[1,0,1] neg_lo:[0,1,0]
    ds_write_addtid_b32 v155 offset:11872
    v_cvt_pk_bf16_f32 v157, v162, v163
    v_pk_mul_f32 v[148:149], v[164:165], v[136:137] op_sel:[0,0] op_sel_hi:[0,1]
    v_pk_mul_f32 v[150:151], v[166:167], v[138:139] op_sel:[0,0] op_sel_hi:[0,1]
    ds_write_addtid_b32 v156 offset:12144
    v_cvt_pk_bf16_f32 v152, v164, v165
    v_pk_fma_f32 v[160:161], v[164:165], v[136:137], v[148:149] op_sel:[1,1,0] op_sel_hi:[1,0,1] neg_lo:[0,1,0]
    v_pk_fma_f32 v[162:163], v[166:167], v[138:139], v[150:151] op_sel:[1,1,0] op_sel_hi:[1,0,1] neg_lo:[0,1,0]
    ds_write_addtid_b32 v157 offset:12400
    v_cvt_pk_bf16_f32 v153, v166, v167
    v_pk_mul_f32 v[148:149], v[160:161], v[136:137] op_sel:[0,0] op_sel_hi:[0,1]
    v_pk_mul_f32 v[150:151], v[162:163], v[138:139] op_sel:[0,0] op_sel_hi:[0,1]
    ds_write_addtid_b32 v152 offset:12672
    v_cvt_pk_bf16_f32 v154, v160, v161
    v_pk_fma_f32 v[164:165], v[160:161], v[136:137], v[148:149] op_sel:[1,1,0] op_sel_hi:[1,0,1] neg_lo:[0,1,0]
    v_pk_fma_f32 v[166:167], v[162:163], v[138:139], v[150:151] op_sel:[1,1,0] op_sel_hi:[1,0,1] neg_lo:[0,1,0]
    ds_write_addtid_b32 v153 offset:12928
    v_cvt_pk_bf16_f32 v155, v162, v163
    v_pk_mul_f32 v[148:149], v[164:165], v[136:137] op_sel:[0,0] op_sel_hi:[0,1]
    v_pk_mul_f32 v[150:151], v[166:167], v[138:139] op_sel:[0,0] op_sel_hi:[0,1]
    ds_write_addtid_b32 v154 offset:13200
    v_cvt_pk_bf16_f32 v156, v164, v165
    v_pk_fma_f32 v[160:161], v[164:165], v[136:137], v[148:149] op_sel:[1,1,0] op_sel_hi:[1,0,1] neg_lo:[0,1,0]
    v_pk_fma_f32 v[162:163], v[166:167], v[138:139], v[150:151] op_sel:[1,1,0] op_sel_hi:[1,0,1] neg_lo:[0,1,0]
    ds_write_addtid_b32 v155 offset:13456
    v_cvt_pk_bf16_f32 v157, v166, v167
    v_pk_mul_f32 v[148:149], v[160:161], v[136:137] op_sel:[0,0] op_sel_hi:[0,1]
    v_pk_mul_f32 v[150:151], v[162:163], v[138:139] op_sel:[0,0] op_sel_hi:[0,1]
    ds_write_addtid_b32 v156 offset:13728
    v_cvt_pk_bf16_f32 v152, v160, v161
    v_pk_fma_f32 v[164:165], v[160:161], v[136:137], v[148:149] op_sel:[1,1,0] op_sel_hi:[1,0,1] neg_lo:[0,1,0]
    v_pk_fma_f32 v[166:167], v[162:163], v[138:139], v[150:151] op_sel:[1,1,0] op_sel_hi:[1,0,1] neg_lo:[0,1,0]
    ds_write_addtid_b32 v157 offset:13984
    v_cvt_pk_bf16_f32 v153, v162, v163
    v_pk_mul_f32 v[148:149], v[164:165], v[136:137] op_sel:[0,0] op_sel_hi:[0,1]
    v_pk_mul_f32 v[150:151], v[166:167], v[138:139] op_sel:[0,0] op_sel_hi:[0,1]
    ds_write_addtid_b32 v152 offset:14256
    v_cvt_pk_bf16_f32 v154, v164, v165
    v_pk_fma_f32 v[160:161], v[164:165], v[136:137], v[148:149] op_sel:[1,1,0] op_sel_hi:[1,0,1] neg_lo:[0,1,0]
    v_pk_fma_f32 v[162:163], v[166:167], v[138:139], v[150:151] op_sel:[1,1,0] op_sel_hi:[1,0,1] neg_lo:[0,1,0]
    ds_write_addtid_b32 v153 offset:14512
    v_cvt_pk_bf16_f32 v155, v166, v167
    v_pk_mul_f32 v[148:149], v[160:161], v[136:137] op_sel:[0,0] op_sel_hi:[0,1]
    v_pk_mul_f32 v[150:151], v[162:163], v[138:139] op_sel:[0,0] op_sel_hi:[0,1]
    ds_write_addtid_b32 v154 offset:14784
    v_cvt_pk_bf16_f32 v156, v160, v161
    v_pk_fma_f32 v[164:165], v[160:161], v[136:137], v[148:149] op_sel:[1,1,0] op_sel_hi:[1,0,1] neg_lo:[0,1,0]
    v_pk_fma_f32 v[166:167], v[162:163], v[138:139], v[150:151] op_sel:[1,1,0] op_sel_hi:[1,0,1] neg_lo:[0,1,0]
    ds_write_addtid_b32 v155 offset:15040
    v_cvt_pk_bf16_f32 v157, v162, v163
    ds_write_addtid_b32 v156 offset:15312
    v_cvt_pk_bf16_f32 v152, v164, v165
    ds_write_addtid_b32 v157 offset:15568
    v_cvt_pk_bf16_f32 v153, v166, v167
    ds_write_addtid_b32 v152 offset:15840
    ds_write_addtid_b32 v153 offset:16096
    s_waitcnt vmcnt(3)
    ds_read_b128 v[64:67], v53 offset:0
    ds_read_b128 v[68:71], v53 offset:32
    ds_read_b128 v[72:75], v53 offset:64
    ds_read_b128 v[76:79], v53 offset:96
    v_lshlrev_b32 v144, 16, v198
    v_and_b32 v146, 0xffff0000, v198
    v_lshlrev_b32 v145, 16, v199
    v_and_b32 v147, 0xffff0000, v199
    v_pk_mul_f32 v[144:145], v[144:145], v[200:201] op_sel:[0,0] op_sel_hi:[1,0]
    ds_read_b128 v[80:83], v53 offset:128
    ds_read_b128 v[84:87], v53 offset:160
    v_pk_mul_f32 v[146:147], v[146:147], v[200:201] op_sel:[0,0] op_sel_hi:[1,0]
    v_fract_f32 v209, v205
    v_fract_f32 v211, v207
    v_exp_f32 v208, v204
    v_cos_f32 v132, v209
    ds_read_b128 v[88:91], v53 offset:192
    ds_read_b128 v[92:95], v53 offset:224
    v_sin_f32 v133, v209
    v_exp_f32 v210, v206
    v_cos_f32 v134, v211
    v_sin_f32 v135, v211
    v_pk_mul_f32 v[132:133], v[132:133], v[208:209] op_sel:[0,0] op_sel_hi:[1,0]
    ds_read_b128 v[96:99], v53 offset:256
    ds_read_b128 v[100:103], v53 offset:288
    v_pk_mul_f32 v[134:135], v[134:135], v[210:211] op_sel:[0,0] op_sel_hi:[1,0]
    v_mul_f32 v208, 0x43800000, v204
    v_mul_f32 v209, 0x43800000, v205
    v_mul_f32 v210, 0x43800000, v206
    v_mul_f32 v211, 0x43800000, v207
    ds_read_b128 v[104:107], v53 offset:320
    ds_read_b128 v[108:111], v53 offset:352
    v_fract_f32 v209, v209
    v_fract_f32 v211, v211
    v_exp_f32 v208, v208
    v_cos_f32 v140, v209
    v_sin_f32 v141, v209
    ds_read_b128 v[112:115], v53 offset:384
    ds_read_b128 v[116:119], v53 offset:416
    v_exp_f32 v210, v210
    v_cos_f32 v142, v211
    v_sin_f32 v143, v211
    v_pk_mul_f32 v[140:141], v[140:141], v[208:209] op_sel:[0,0] op_sel_hi:[1,0]
    v_pk_mul_f32 v[142:143], v[142:143], v[210:211] op_sel:[0,0] op_sel_hi:[1,0]
    ds_read_b128 v[120:123], v53 offset:448
    ds_read_b128 v[124:127], v53 offset:480
    s_setprio 1
.p2align 3
    v_pk_mul_f32 v[148:149], v[144:145], v[132:133] op_sel:[0,0] op_sel_hi:[0,1]
    v_pk_mul_f32 v[150:151], v[146:147], v[134:135] op_sel:[0,0] op_sel_hi:[0,1]
    s_load_dwordx2 s[66:67], s[44:45], 0
    v_cvt_pk_bf16_f32 v154, v144, -v145
    v_pk_fma_f32 v[160:161], v[144:145], v[132:133], v[148:149] op_sel:[1,1,0] op_sel_hi:[1,0,1] neg_lo:[0,1,0]
    v_pk_fma_f32 v[162:163], v[146:147], v[134:135], v[150:151] op_sel:[1,1,0] op_sel_hi:[1,0,1] neg_lo:[0,1,0]
    v_cvt_pk_bf16_f32 v155, v146, -v147
    v_pk_mul_f32 v[148:149], v[160:161], v[132:133] op_sel:[0,0] op_sel_hi:[0,1]
    v_pk_mul_f32 v[150:151], v[162:163], v[134:135] op_sel:[0,0] op_sel_hi:[0,1]
    ds_write_addtid_b32 v154 offset:0
    v_cvt_pk_bf16_f32 v156, v160, -v161
    v_pk_fma_f32 v[168:169], v[160:161], v[132:133], v[148:149] op_sel:[1,1,0] op_sel_hi:[1,0,1] neg_lo:[0,1,0]
    v_pk_fma_f32 v[170:171], v[162:163], v[134:135], v[150:151] op_sel:[1,1,0] op_sel_hi:[1,0,1] neg_lo:[0,1,0]
    ds_write_addtid_b32 v155 offset:256
    v_cvt_pk_bf16_f32 v157, v162, -v163
    v_pk_mul_f32 v[148:149], v[168:169], v[132:133] op_sel:[0,0] op_sel_hi:[0,1]
    v_pk_mul_f32 v[150:151], v[170:171], v[134:135] op_sel:[0,0] op_sel_hi:[0,1]
    ds_write_addtid_b32 v156 offset:528
    v_cvt_pk_bf16_f32 v152, v168, -v169
    v_pk_fma_f32 v[164:165], v[168:169], v[132:133], v[148:149] op_sel:[1,1,0] op_sel_hi:[1,0,1] neg_lo:[0,1,0]
    v_pk_fma_f32 v[166:167], v[170:171], v[134:135], v[150:151] op_sel:[1,1,0] op_sel_hi:[1,0,1] neg_lo:[0,1,0]
    ds_write_addtid_b32 v157 offset:784
    v_cvt_pk_bf16_f32 v153, v170, -v171
    v_pk_mul_f32 v[148:149], v[164:165], v[132:133] op_sel:[0,0] op_sel_hi:[0,1]
    v_pk_mul_f32 v[150:151], v[166:167], v[134:135] op_sel:[0,0] op_sel_hi:[0,1]
    ds_write_addtid_b32 v152 offset:1056
    v_cvt_pk_bf16_f32 v154, v164, -v165
    v_pk_fma_f32 v[172:173], v[164:165], v[132:133], v[148:149] op_sel:[1,1,0] op_sel_hi:[1,0,1] neg_lo:[0,1,0]
    v_pk_fma_f32 v[174:175], v[166:167], v[134:135], v[150:151] op_sel:[1,1,0] op_sel_hi:[1,0,1] neg_lo:[0,1,0]
    ds_write_addtid_b32 v153 offset:1312
    v_cvt_pk_bf16_f32 v155, v166, -v167
    v_pk_mul_f32 v[148:149], v[172:173], v[132:133] op_sel:[0,0] op_sel_hi:[0,1]
    v_pk_mul_f32 v[150:151], v[174:175], v[134:135] op_sel:[0,0] op_sel_hi:[0,1]
    ds_write_addtid_b32 v154 offset:1584
    v_cvt_pk_bf16_f32 v156, v172, -v173
    v_pk_fma_f32 v[160:161], v[172:173], v[132:133], v[148:149] op_sel:[1,1,0] op_sel_hi:[1,0,1] neg_lo:[0,1,0]
    v_pk_fma_f32 v[162:163], v[174:175], v[134:135], v[150:151] op_sel:[1,1,0] op_sel_hi:[1,0,1] neg_lo:[0,1,0]
    ds_write_addtid_b32 v155 offset:1840
    v_cvt_pk_bf16_f32 v157, v174, -v175
    v_pk_mul_f32 v[148:149], v[160:161], v[132:133] op_sel:[0,0] op_sel_hi:[0,1]
    v_pk_mul_f32 v[150:151], v[162:163], v[134:135] op_sel:[0,0] op_sel_hi:[0,1]
    ds_write_addtid_b32 v156 offset:5808
    ds_write_addtid_b32 v156 offset:2112
    buffer_load_dwordx4 v[236:239], v48, s[48:51], s60 offen offset:2048
    v_cvt_pk_bf16_f32 v152, v160, -v161
    v_pk_fma_f32 v[176:177], v[160:161], v[132:133], v[148:149] op_sel:[1,1,0] op_sel_hi:[1,0,1] neg_lo:[0,1,0]
    v_pk_fma_f32 v[178:179], v[162:163], v[134:135], v[150:151] op_sel:[1,1,0] op_sel_hi:[1,0,1] neg_lo:[0,1,0]
    ds_write_addtid_b32 v157 offset:6064
    ds_write_addtid_b32 v157 offset:2368
    v_cvt_pk_bf16_f32 v153, v162, -v163
    v_pk_mul_f32 v[148:149], v[176:177], v[132:133] op_sel:[0,0] op_sel_hi:[0,1]
    v_pk_mul_f32 v[150:151], v[178:179], v[134:135] op_sel:[0,0] op_sel_hi:[0,1]
    ds_write_addtid_b32 v152 offset:2640
    v_cvt_pk_bf16_f32 v154, v176, -v177
    v_pk_fma_f32 v[164:165], v[176:177], v[132:133], v[148:149] op_sel:[1,1,0] op_sel_hi:[1,0,1] neg_lo:[0,1,0]
    v_pk_fma_f32 v[166:167], v[178:179], v[134:135], v[150:151] op_sel:[1,1,0] op_sel_hi:[1,0,1] neg_lo:[0,1,0]
    ds_write_addtid_b32 v153 offset:2896
    v_cvt_pk_bf16_f32 v155, v178, -v179
    v_pk_mul_f32 v[148:149], v[164:165], v[132:133] op_sel:[0,0] op_sel_hi:[0,1]
    v_pk_mul_f32 v[150:151], v[166:167], v[134:135] op_sel:[0,0] op_sel_hi:[0,1]
    ds_write_addtid_b32 v154 offset:3168
    v_cvt_pk_bf16_f32 v156, v164, -v165
    v_pk_fma_f32 v[180:181], v[164:165], v[132:133], v[148:149] op_sel:[1,1,0] op_sel_hi:[1,0,1] neg_lo:[0,1,0]
    v_pk_fma_f32 v[182:183], v[166:167], v[134:135], v[150:151] op_sel:[1,1,0] op_sel_hi:[1,0,1] neg_lo:[0,1,0]
    ds_write_addtid_b32 v155 offset:3424
    v_cvt_pk_bf16_f32 v157, v166, -v167
    v_pk_mul_f32 v[148:149], v[180:181], v[140:141] op_sel:[0,0] op_sel_hi:[0,1]
    v_pk_mul_f32 v[150:151], v[182:183], v[142:143] op_sel:[0,0] op_sel_hi:[0,1]
    ds_write_addtid_b32 v156 offset:3696
    v_cvt_pk_bf16_f32 v152, v180, -v181
    v_pk_fma_f32 v[160:161], v[180:181], v[140:141], v[148:149] op_sel:[1,1,0] op_sel_hi:[1,0,1] neg_lo:[0,1,0]
    v_pk_fma_f32 v[162:163], v[182:183], v[142:143], v[150:151] op_sel:[1,1,0] op_sel_hi:[1,0,1] neg_lo:[0,1,0]
    ds_write_addtid_b32 v157 offset:3952
    v_cvt_pk_bf16_f32 v153, v182, -v183
    v_pk_mul_f32 v[148:149], v[172:173], v[140:141] op_sel:[0,0] op_sel_hi:[0,1]
    v_pk_mul_f32 v[150:151], v[174:175], v[142:143] op_sel:[0,0] op_sel_hi:[0,1]
    ds_write_addtid_b32 v152 offset:7920
    v_cvt_pk_bf16_f32 v154, v160, -v161
    v_pk_fma_f32 v[164:165], v[172:173], v[140:141], v[148:149] op_sel:[1,1,0] op_sel_hi:[1,0,1] neg_lo:[0,1,0]
    v_pk_fma_f32 v[166:167], v[174:175], v[142:143], v[150:151] op_sel:[1,1,0] op_sel_hi:[1,0,1] neg_lo:[0,1,0]
    ds_write_addtid_b32 v153 offset:8176
    v_cvt_pk_bf16_f32 v155, v162, -v163
    v_pk_mul_f32 v[148:149], v[160:161], v[140:141] op_sel:[0,0] op_sel_hi:[0,1]
    v_pk_mul_f32 v[150:151], v[162:163], v[142:143] op_sel:[0,0] op_sel_hi:[0,1]
    ds_write_addtid_b32 v154 offset:7392
    v_cvt_pk_bf16_f32 v156, v164, -v165
    v_pk_fma_f32 v[180:181], v[160:161], v[140:141], v[148:149] op_sel:[1,1,0] op_sel_hi:[1,0,1] neg_lo:[0,1,0]
    v_pk_fma_f32 v[182:183], v[162:163], v[142:143], v[150:151] op_sel:[1,1,0] op_sel_hi:[1,0,1] neg_lo:[0,1,0]
    ds_write_addtid_b32 v155 offset:7648
    v_cvt_pk_bf16_f32 v157, v166, -v167
    v_pk_mul_f32 v[148:149], v[164:165], v[140:141] op_sel:[0,0] op_sel_hi:[0,1]
    v_pk_mul_f32 v[150:151], v[166:167], v[142:143] op_sel:[0,0] op_sel_hi:[0,1]
    ds_write_addtid_b32 v156 offset:5280
    ds_write_addtid_b32 v156 offset:6336
    v_cvt_pk_bf16_f32 v152, v180, -v181
    v_pk_fma_f32 v[172:173], v[164:165], v[140:141], v[148:149] op_sel:[1,1,0] op_sel_hi:[1,0,1] neg_lo:[0,1,0]
    v_pk_fma_f32 v[174:175], v[166:167], v[142:143], v[150:151] op_sel:[1,1,0] op_sel_hi:[1,0,1] neg_lo:[0,1,0]
    ds_write_addtid_b32 v157 offset:5536
    ds_write_addtid_b32 v157 offset:6592
    v_cvt_pk_bf16_f32 v153, v182, -v183
    v_pk_mul_f32 v[148:149], v[180:181], v[140:141] op_sel:[0,0] op_sel_hi:[0,1]
    v_pk_mul_f32 v[150:151], v[182:183], v[142:143] op_sel:[0,0] op_sel_hi:[0,1]
    ds_write_addtid_b32 v152 offset:8976
    v_cvt_pk_bf16_f32 v154, v172, -v173
    v_pk_fma_f32 v[160:161], v[180:181], v[140:141], v[148:149] op_sel:[1,1,0] op_sel_hi:[1,0,1] neg_lo:[0,1,0]
    v_pk_fma_f32 v[162:163], v[182:183], v[142:143], v[150:151] op_sel:[1,1,0] op_sel_hi:[1,0,1] neg_lo:[0,1,0]
    ds_write_addtid_b32 v153 offset:9232
    v_cvt_pk_bf16_f32 v155, v174, -v175
    v_pk_mul_f32 v[148:149], v[172:173], v[140:141] op_sel:[0,0] op_sel_hi:[0,1]
    v_pk_mul_f32 v[150:151], v[174:175], v[142:143] op_sel:[0,0] op_sel_hi:[0,1]
    ds_write_addtid_b32 v154 offset:8448
    v_cvt_pk_bf16_f32 v156, v160, -v161
    v_pk_fma_f32 v[164:165], v[172:173], v[140:141], v[148:149] op_sel:[1,1,0] op_sel_hi:[1,0,1] neg_lo:[0,1,0]
    v_pk_fma_f32 v[166:167], v[174:175], v[142:143], v[150:151] op_sel:[1,1,0] op_sel_hi:[1,0,1] neg_lo:[0,1,0]
    ds_write_addtid_b32 v155 offset:8704
    v_cvt_pk_bf16_f32 v157, v162, -v163
    v_pk_mul_f32 v[148:149], v[160:161], v[140:141] op_sel:[0,0] op_sel_hi:[0,1]
    v_pk_mul_f32 v[150:151], v[162:163], v[142:143] op_sel:[0,0] op_sel_hi:[0,1]
    ds_write_addtid_b32 v156 offset:11088
    v_cvt_pk_bf16_f32 v152, v164, -v165
    v_pk_fma_f32 v[180:181], v[160:161], v[140:141], v[148:149] op_sel:[1,1,0] op_sel_hi:[1,0,1] neg_lo:[0,1,0]
    v_pk_fma_f32 v[182:183], v[162:163], v[142:143], v[150:151] op_sel:[1,1,0] op_sel_hi:[1,0,1] neg_lo:[0,1,0]
    ds_write_addtid_b32 v157 offset:11344
    v_cvt_pk_bf16_f32 v153, v166, -v167
    v_pk_mul_f32 v[148:149], v[144:145], v[140:141] op_sel:[0,0] op_sel_hi:[0,1]
    v_pk_mul_f32 v[150:151], v[146:147], v[142:143] op_sel:[0,0] op_sel_hi:[0,1]
    ds_write_addtid_b32 v152 offset:10560
    v_cvt_pk_bf16_f32 v154, v180, -v181
    v_pk_fma_f32 v[184:185], v[144:145], v[140:141], v[148:149] op_sel:[1,1,0] op_sel_hi:[1,0,1] neg_lo:[0,1,0]
    v_pk_fma_f32 v[186:187], v[146:147], v[142:143], v[150:151] op_sel:[1,1,0] op_sel_hi:[1,0,1] neg_lo:[0,1,0]
    ds_write_addtid_b32 v153 offset:10816
    v_cvt_pk_bf16_f32 v155, v182, -v183
    v_pk_mul_f32 v[148:149], v[180:181], v[140:141] op_sel:[0,0] op_sel_hi:[0,1]
    v_pk_mul_f32 v[150:151], v[182:183], v[142:143] op_sel:[0,0] op_sel_hi:[0,1]
    ds_write_addtid_b32 v154 offset:9504
    v_cvt_pk_bf16_f32 v156, v184, -v185
    v_pk_fma_f32 v[160:161], v[180:181], v[140:141], v[148:149] op_sel:[1,1,0] op_sel_hi:[1,0,1] neg_lo:[0,1,0]
    v_pk_fma_f32 v[162:163], v[182:183], v[142:143], v[150:151] op_sel:[1,1,0] op_sel_hi:[1,0,1] neg_lo:[0,1,0]
    ds_write_addtid_b32 v155 offset:9760
    v_cvt_pk_bf16_f32 v157, v186, -v187
    v_pk_mul_f32 v[148:149], v[168:169], v[140:141] op_sel:[0,0] op_sel_hi:[0,1]
    v_pk_mul_f32 v[150:151], v[170:171], v[142:143] op_sel:[0,0] op_sel_hi:[0,1]
    ds_write_addtid_b32 v156 offset:4224
    v_cvt_pk_bf16_f32 v152, v160, -v161
    v_pk_fma_f32 v[184:185], v[168:169], v[140:141], v[148:149] op_sel:[1,1,0] op_sel_hi:[1,0,1] neg_lo:[0,1,0]
    v_pk_fma_f32 v[186:187], v[170:171], v[142:143], v[150:151] op_sel:[1,1,0] op_sel_hi:[1,0,1] neg_lo:[0,1,0]
    ds_write_addtid_b32 v157 offset:4480
    v_cvt_pk_bf16_f32 v153, v162, -v163
    v_pk_mul_f32 v[148:149], v[160:161], v[140:141] op_sel:[0,0] op_sel_hi:[0,1]
    v_pk_mul_f32 v[150:151], v[162:163], v[142:143] op_sel:[0,0] op_sel_hi:[0,1]
    ds_write_addtid_b32 v152 offset:10032
    v_cvt_pk_bf16_f32 v154, v184, -v185
    v_pk_fma_f32 v[180:181], v[160:161], v[140:141], v[148:149] op_sel:[1,1,0] op_sel_hi:[1,0,1] neg_lo:[0,1,0]
    v_pk_fma_f32 v[182:183], v[162:163], v[142:143], v[150:151] op_sel:[1,1,0] op_sel_hi:[1,0,1] neg_lo:[0,1,0]
    ds_write_addtid_b32 v153 offset:10288
    v_cvt_pk_bf16_f32 v155, v186, -v187
    v_pk_mul_f32 v[148:149], v[176:177], v[140:141] op_sel:[0,0] op_sel_hi:[0,1]
    v_pk_mul_f32 v[150:151], v[178:179], v[142:143] op_sel:[0,0] op_sel_hi:[0,1]
    ds_write_addtid_b32 v154 offset:4752
    v_cvt_pk_bf16_f32 v156, v180, -v181
    v_pk_fma_f32 v[184:185], v[176:177], v[140:141], v[148:149] op_sel:[1,1,0] op_sel_hi:[1,0,1] neg_lo:[0,1,0]
    v_pk_fma_f32 v[186:187], v[178:179], v[142:143], v[150:151] op_sel:[1,1,0] op_sel_hi:[1,0,1] neg_lo:[0,1,0]
    ds_write_addtid_b32 v155 offset:5008
    v_cvt_pk_bf16_f32 v157, v182, -v183
    v_pk_mul_f32 v[148:149], v[180:181], v[140:141] op_sel:[0,0] op_sel_hi:[0,1]
    v_pk_mul_f32 v[150:151], v[182:183], v[142:143] op_sel:[0,0] op_sel_hi:[0,1]
    ds_write_addtid_b32 v156 offset:11616
    v_cvt_pk_bf16_f32 v152, v184, -v185
    v_pk_fma_f32 v[160:161], v[180:181], v[140:141], v[148:149] op_sel:[1,1,0] op_sel_hi:[1,0,1] neg_lo:[0,1,0]
    v_pk_fma_f32 v[162:163], v[182:183], v[142:143], v[150:151] op_sel:[1,1,0] op_sel_hi:[1,0,1] neg_lo:[0,1,0]
    ds_write_addtid_b32 v157 offset:11872
    v_cvt_pk_bf16_f32 v153, v186, -v187
    ds_write_addtid_b32 v152 offset:6864
    v_cvt_pk_bf16_f32 v154, v160, -v161
    ds_write_addtid_b32 v153 offset:7120
    v_cvt_pk_bf16_f32 v155, v162, -v163
    ds_write_addtid_b32 v154 offset:12144
    ds_write_addtid_b32 v155 offset:12400
    v_mov_b32 v0, v48
    s_bitcmp1_b32 s3, 2
    s_cbranch_scc1 LC_path2
    buffer_load_dwordx4 v[248:251], v0, s[48:51], s8 offen offset:0
    ds_read_b128 v[132:135], v49 offset:0
    ds_read_b128 v[136:139], v49 offset:32
    ds_read_b128 v[140:143], v49 offset:64
    ds_read_b128 v[144:147], v49 offset:96
    ds_read_b128 v[148:151], v49 offset:128
    ds_read_b128 v[152:155], v49 offset:160
    s_waitcnt lgkmcnt(5)
    v_mfma_f32_32x32x16_bf16 v[32:47], v[132:135], v[64:67], 0
    ds_read_b128 v[156:159], v49 offset:192
    ds_read_b128 v[160:163], v49 offset:224
    v_lshlrev_b32 v58, 5, v59
    v_sub_u32 v3, s18, v58
    s_waitcnt lgkmcnt(6)
    v_mfma_f32_32x32x16_bf16 v[32:47], v[136:139], v[68:71], v[32:47]
    ds_read_b128 v[164:167], v49 offset:256
    ds_read_b128 v[168:171], v49 offset:288
    v_lshl_add_u32 v2, v7, 4, v3
    v_lshlrev_b32 v5, 3, v7
    s_waitcnt lgkmcnt(7)
    v_mfma_f32_32x32x16_bf16 v[32:47], v[140:143], v[72:75], v[32:47]
    ds_read_b128 v[172:175], v49 offset:320
    ds_read_b128 v[176:179], v49 offset:352
    v_sub_u32 v3, v3, v5
    v_mul_u32_u24 v5, 144, v7
    s_waitcnt lgkmcnt(8)
    v_mfma_f32_32x32x16_bf16 v[32:47], v[144:147], v[76:79], v[32:47]
    ds_read_b128 v[180:183], v49 offset:384
    ds_read_b128 v[184:187], v49 offset:416
    v_lshl_add_u32 v58, v59, 3, s61
    v_add_u32 v5, v5, v58
    s_waitcnt lgkmcnt(9)
    v_mfma_f32_32x32x16_bf16 v[32:47], v[148:151], v[80:83], v[32:47]
    ds_read_b128 v[188:191], v49 offset:448
    ds_read_b128 v[192:195], v49 offset:480
    v_lshl_add_u32 v50, v56, 4, s61
    v_lshl_add_u32 v50, v57, 3, v50
    s_waitcnt lgkmcnt(10)
    v_mfma_f32_32x32x16_bf16 v[32:47], v[152:155], v[84:87], v[32:47]
    ds_write_addtid_b32 v54 offset:4608
    ds_write_addtid_b32 v54 offset:5664
    v_lshl_add_u32 v52, v56, 1, s61
    v_lshl_add_u32 v52, v57, 7, v52
    s_waitcnt lgkmcnt(11)
    v_mfma_f32_32x32x16_bf16 v[32:47], v[156:159], v[88:91], v[32:47]
    ds_write_addtid_b32 v54 offset:6896
    ds_write_addtid_b32 v54 offset:7152
    v_lshrrev_b32 v56, 1, v56
    v_lshl_add_u32 v51, v56, 2, s61
    s_waitcnt lgkmcnt(12)
    v_mfma_f32_32x32x16_bf16 v[32:47], v[160:163], v[92:95], v[32:47]
    v_lshl_add_u32 v51, v57, 6, v51
    v_add_u32 v56, 192, v51
    v_cndmask_b32 v51, v51, v56, s[14:15]
    v_and_b32 v56, 14, v1
    s_waitcnt lgkmcnt(4)
    v_mfma_f32_32x32x16_bf16 v[32:47], v[164:167], v[96:99], v[32:47]
    v_lshlrev_b32 v56, 1, v56
    v_lshl_add_u32 v56, v7, 4, v56
    v_mov_b32 v57, 5832
    v_mov_b32 v58, 4612
    v_cndmask_b32 v57, v57, v58, s[14:15]
    v_mfma_f32_32x32x16_bf16 v[32:47], v[168:171], v[100:103], v[32:47]
    v_add3_u32 v60, v56, v57, s61
    v_add_u32 v61, 1024, v60
    v_lshlrev_b32 v56, 4, v7
    v_lshl_add_u32 v62, v59, 2, s19
    v_sub_u32 v62, v62, v56
    v_mfma_f32_32x32x16_bf16 v[32:47], v[172:175], v[104:107], v[32:47]
    v_lshl_add_u32 v247, v1, 4, s20
    v_bfe_u32 v56, v1, 2, 2
    v_mul_u32_u24 v8, 19008, v56
    v_and_b32 v56, 3, v1
    v_mul_u32_u24 v56, 144, v56
    v_mfma_f32_32x32x16_bf16 v[32:47], v[176:179], v[108:111], v[32:47]
    v_lshl_add_u32 v57, v7, 3, s21
    v_add3_u32 v8, v8, v56, v57
    v_add_u32 v9, 76032, v8
    v_and_b32 v56, 1, v1
    v_lshl_add_u32 v6, v56, 3, s22
    v_mfma_f32_32x32x16_bf16 v[32:47], v[180:183], v[112:115], v[32:47]
    v_bfe_u32 v56, v1, 1, 2
    v_lshl_add_u32 v6, v56, 8, v6
    v_lshrrev_b32 v56, 3, v1
    v_lshl_add_u32 v6, v56, 4, v6
    v_lshl_add_u32 v246, v1, 7, s23
    v_mfma_f32_32x32x16_bf16 v[32:47], v[184:187], v[116:119], v[32:47]
    v_bfe_u32 v56, v1, 3, 1
    v_lshl_add_u32 v56, v56, 2, v7
    v_lshlrev_b32 v56, 3, v56
    v_add_u32 v56, 131072, v56
    v_lshl_add_u32 v7, v1, 4, s24
    v_mfma_f32_32x32x16_bf16 v[32:47], v[188:191], v[120:123], v[32:47]
    v_cndmask_b32 v7, v7, v56, s[30:31]
    v_mfma_f32_32x32x16_bf16 v[32:47], v[192:195], v[124:127], v[32:47]
    s_setprio 0
    s_waitcnt lgkmcnt(0)
    s_nop 10
    v_add_f32 v32, v32, v55
    v_cvt_pk_bf16_f32 v65, v34, v35
    v_cvt_pk_bf16_f32 v64, v32, v33
    v_cvt_pk_bf16_f32 v66, v36, v36
    v_cvt_pk_bf16_f32 v67, v37, v38
    v_cvt_pk_bf16_f32 v68, v33, v34
    v_cvt_pk_bf16_f32 v69, v35, v39
    v_cvt_pk_bf16_f32 v70, v36, v37
    v_cvt_pk_bf16_f32 v71, v38, v38
    v_lshlrev_b32 v72, 16, v64
    v_mov_b32 v74, v71
    v_and_b32 v75, 0xffff, v71
    v_cvt_pk_bf16_f32 v58, v41, v41
    v_cvt_pk_bf16_f32 v56, v40, v41
    v_cvt_pk_bf16_f32 v57, v42, v43
    v_readlane_b32 s6, v58, 63
    ds_write_b64 v50, v[64:65] offset:4640
    ds_write_b64 v50, v[68:69] offset:5864
    ds_write_b64 v50, v[66:67] offset:5152
    ds_write_b64 v50, v[70:71] offset:6376
    ds_write_b32 v51, v56 offset:7024
    ds_write_b16 v52, v57 offset:7408
    ds_write_b16_d16_hi v52, v57 offset:7472
    s_mov_b64 exec, 1
    ds_write_b32 v50, v72 offset:5860
    s_mov_b32 exec_lo, 0
    s_mov_b32 exec_hi, 0x80000000
    ds_write_b64 v50, v[74:75] offset:5160
    ds_write_b32 v50, v74 offset:6384
    ds_write_b32 v50, v54 offset:6388
    s_mov_b64 exec, -1
    v_and_b32 v28, s6, v28
    v_and_b32 v29, s6, v29
    v_and_b32 v30, s6, v30
    v_and_b32 v31, s6, v31
    ds_read2_b32 v[68:69], v60 offset0:16 offset1:17
    ds_read2_b32 v[70:71], v60 offset0:18 offset1:19
    ds_read2_b32 v[100:101], v60 offset0:144 offset1:145
    ds_read2_b32 v[102:103], v60 offset0:146 offset1:147
    ds_read2_b32 v[72:73], v60 offset0:32 offset1:33
    ds_read2_b32 v[74:75], v60 offset0:34 offset1:35
    ds_read2_b32 v[104:105], v60 offset0:160 offset1:161
    ds_read2_b32 v[106:107], v60 offset0:162 offset1:163
    ds_read2_b32 v[76:77], v60 offset0:48 offset1:49
    ds_read2_b32 v[78:79], v60 offset0:50 offset1:51
    ds_read2_b32 v[108:109], v60 offset0:176 offset1:177
    ds_read2_b32 v[110:111], v60 offset0:178 offset1:179
    ds_read2_b32 v[80:81], v60 offset0:64 offset1:65
    ds_read2_b32 v[82:83], v60 offset0:66 offset1:67
    ds_read2_b32 v[112:113], v60 offset0:192 offset1:193
    ds_read2_b32 v[114:115], v60 offset0:194 offset1:195
    ds_read2_b32 v[84:85], v60 offset0:80 offset1:81
    ds_read2_b32 v[86:87], v60 offset0:82 offset1:83
    ds_read2_b32 v[116:117], v60 offset0:208 offset1:209
    ds_read2_b32 v[118:119], v60 offset0:210 offset1:211
    ds_read2_b32 v[88:89], v60 offset0:96 offset1:97
    ds_read2_b32 v[90:91], v60 offset0:98 offset1:99
    ds_read2_b32 v[120:121], v60 offset0:224 offset1:225
    ds_read2_b32 v[122:123], v60 offset0:226 offset1:227
    ds_read2_b32 v[92:93], v60 offset0:112 offset1:113
    ds_read2_b32 v[94:95], v60 offset0:114 offset1:115
    ds_read2_b32 v[124:125], v60 offset0:240 offset1:241
    ds_read2_b32 v[126:127], v60 offset0:242 offset1:243
    ds_read2_b32 v[64:65], v60 offset0:0 offset1:1
    ds_read2_b32 v[66:67], v60 offset0:2 offset1:3
    ds_read2_b32 v[96:97], v60 offset0:128 offset1:129
    ds_read2_b32 v[98:99], v60 offset0:130 offset1:131
    ds_read2_b32 v[128:129], v61 offset0:0 offset1:1
    ds_read2_b32 v[130:131], v61 offset0:2 offset1:3
    s_waitcnt vmcnt(1)
    v_perm_b32 v196, v232, v236, s64
    v_perm_b32 v197, v232, v236, s65
    v_perm_b32 v198, v233, v237, s64
    v_perm_b32 v199, v233, v237, s65
    v_perm_b32 v200, v234, v238, s64
    v_perm_b32 v201, v234, v238, s65
    v_perm_b32 v202, v235, v239, s64
    v_perm_b32 v203, v235, v239, s65
    s_mov_b32 m0, s68
    s_nop 0
    ds_write_addtid_b32 v196 offset:2048
    ds_write_addtid_b32 v197 offset:21056
    ds_write_addtid_b32 v198 offset:40064
    ds_write_addtid_b32 v199 offset:59072
    s_mov_b32 m0, s69
    s_nop 0
    ds_write_addtid_b32 v200 offset:2048
    ds_write_addtid_b32 v201 offset:21056
    ds_write_addtid_b32 v202 offset:40064
    ds_write_addtid_b32 v203 offset:59072
    s_waitcnt lgkmcnt(0)
    s_barrier
    global_load_dwordx4 v[232:235], v247, s[46:47] offset:0 sc1
    global_load_dwordx4 v[236:239], v247, s[46:47] offset:1024 sc1
    ds_read_b128 v[200:203], v2 offset:3648
    ds_read_b128 v[204:207], v2 offset:3712
    ds_read_b128 v[208:211], v2 offset:3776
    ds_read_b128 v[212:215], v2 offset:3840
    ds_read_b128 v[216:219], v2 offset:3904
    ds_read_b128 v[220:223], v2 offset:3968
    ds_read_b128 v[224:227], v2 offset:4032
    ds_read_b128 v[196:199], v2 offset:3584
    ds_read_b128 v[228:231], v2 offset:3600
    s_waitcnt lgkmcnt(8)
    v_mfma_f32_16x16x32_bf16 v[32:35], v[68:71], v[200:203], 0
    s_mov_b32 m0, s68
    v_mfma_f32_16x16x32_bf16 v[36:39], v[100:103], v[200:203], 0
    ds_read_b128 v[200:203], v2 offset:3136
    s_waitcnt lgkmcnt(8)
    v_mfma_f32_16x16x32_bf16 v[32:35], v[72:75], v[204:207], v[32:35]
    ds_read2_b32 v[132:133], v62 offset0:16 offset1:15
    ds_read2_b32 v[134:135], v62 offset0:14 offset1:13
    v_mfma_f32_16x16x32_bf16 v[36:39], v[104:107], v[204:207], v[36:39]
    ds_read_b128 v[204:207], v2 offset:3200
    s_waitcnt lgkmcnt(4)
    v_mfma_f32_16x16x32_bf16 v[32:35], v[76:79], v[208:211], v[32:35]
    ds_read2_b32 v[144:145], v62 offset0:64 offset1:63
    ds_read2_b32 v[146:147], v62 offset0:62 offset1:61
    v_mfma_f32_16x16x32_bf16 v[36:39], v[108:111], v[208:211], v[36:39]
    ds_read_b128 v[208:211], v2 offset:3264
    ds_read2_b32 v[136:137], v62 offset0:32 offset1:31
    v_mfma_f32_16x16x32_bf16 v[32:35], v[80:83], v[212:215], v[32:35]
    ds_read2_b32 v[138:139], v62 offset0:30 offset1:29
    ds_read2_b32 v[148:149], v62 offset0:80 offset1:79
    v_mfma_f32_16x16x32_bf16 v[36:39], v[112:115], v[212:215], v[36:39]
    ds_read_b128 v[212:215], v2 offset:3328
    ds_read2_b32 v[150:151], v62 offset0:78 offset1:77
    v_mfma_f32_16x16x32_bf16 v[32:35], v[84:87], v[216:219], v[32:35]
    ds_read2_b32 v[140:141], v62 offset0:48 offset1:47
    ds_read2_b32 v[142:143], v62 offset0:46 offset1:45
    v_mfma_f32_16x16x32_bf16 v[36:39], v[116:119], v[216:219], v[36:39]
    ds_read_b128 v[216:219], v2 offset:3392
    ds_read2_b32 v[152:153], v62 offset0:96 offset1:95
    v_mfma_f32_16x16x32_bf16 v[32:35], v[88:91], v[220:223], v[32:35]
    ds_read2_b32 v[154:155], v62 offset0:94 offset1:93
    ds_read2_b32 v[156:157], v62 offset0:112 offset1:111
    v_mfma_f32_16x16x32_bf16 v[36:39], v[120:123], v[220:223], v[36:39]
    buffer_load_dwordx4 v[252:255], v0, s[48:51], s8 offen offset:2048
    v_mfma_f32_16x16x32_bf16 v[32:35], v[92:95], v[224:227], v[32:35]
    ds_read_b128 v[220:223], v2 offset:3456
    ds_read2_b32 v[158:159], v62 offset0:110 offset1:109
    v_mfma_f32_16x16x32_bf16 v[36:39], v[124:127], v[224:227], v[36:39]
    ds_read_b128 v[224:227], v2 offset:3520
    ds_read2_b32 v[160:161], v62 offset0:128 offset1:127
    v_mfma_f32_16x16x32_bf16 v[32:35], v[64:67], v[196:199], v[32:35]
    ds_read2_b32 v[162:163], v62 offset0:126 offset1:125
    ds_read2_b32 v[164:165], v62 offset0:144 offset1:143
    v_mfma_f32_16x16x32_bf16 v[36:39], v[96:99], v[196:199], v[36:39]
    ds_read2_b32 v[166:167], v62 offset0:142 offset1:141
    ds_read2_b32 v[168:169], v62 offset0:160 offset1:159
    v_mfma_f32_16x16x32_bf16 v[40:43], v[128:131], v[196:199], 0
    ds_read2_b32 v[170:171], v62 offset0:158 offset1:157
    v_mfma_f32_16x16x32_bf16 v[48:51], v[28:31], v[196:199], 0
    v_mfma_f32_16x16x32_bf16 v[172:175], v[196:199], v[12:15], 0
    v_mfma_f32_16x16x32_bf16 v[176:179], v[196:199], v[16:19], 0
    v_mfma_f32_16x16x32_bf16 v[188:191], v[196:199], v[20:23], 0
    ds_read_b128 v[196:199], v2 offset:3072
    v_mfma_f32_16x16x32_bf16 v[180:183], v[228:231], v[12:15], 0
    v_mfma_f32_16x16x32_bf16 v[184:187], v[228:231], v[16:19], 0
    v_mfma_f32_16x16x32_bf16 v[192:195], v[228:231], v[24:27], 0
    ds_read_b128 v[228:231], v2 offset:3088
    s_waitcnt lgkmcnt(2)
    v_mfma_f32_16x16x32_bf16 v[36:39], v[68:71], v[200:203], v[36:39]
    v_cvt_pk_bf16_f32 v172, v172, v176
    v_cvt_pk_bf16_f32 v173, v173, v177
    v_mfma_f32_16x16x32_bf16 v[40:43], v[100:103], v[200:203], v[40:43]
    v_cvt_pk_bf16_f32 v174, v174, v178
    v_cvt_pk_bf16_f32 v175, v175, v179
    v_mfma_f32_16x16x32_bf16 v[36:39], v[72:75], v[204:207], v[36:39]
    ds_read_b128 v[200:203], v2 offset:2624
    v_cvt_pk_bf16_f32 v180, v180, v184
    v_mfma_f32_16x16x32_bf16 v[40:43], v[104:107], v[204:207], v[40:43]
    v_cvt_pk_bf16_f32 v181, v181, v185
    v_cvt_pk_bf16_f32 v182, v182, v186
    v_mfma_f32_16x16x32_bf16 v[36:39], v[76:79], v[208:211], v[36:39]
    v_cvt_pk_bf16_f32 v183, v183, v187
    v_cvt_pk_bf16_f32 v188, v188, v192
    v_mfma_f32_16x16x32_bf16 v[40:43], v[108:111], v[208:211], v[40:43]
    ds_read_b128 v[204:207], v2 offset:2688
    v_cvt_pk_bf16_f32 v189, v189, v193
    v_mfma_f32_16x16x32_bf16 v[36:39], v[80:83], v[212:215], v[36:39]
    ds_read_b128 v[208:211], v2 offset:2752
    v_cvt_pk_bf16_f32 v190, v190, v194
    v_mfma_f32_16x16x32_bf16 v[40:43], v[112:115], v[212:215], v[40:43]
    v_cvt_pk_bf16_f32 v191, v191, v195
    v_mfma_f32_16x16x32_bf16 v[36:39], v[84:87], v[216:219], v[36:39]
    ds_read_b128 v[212:215], v2 offset:2816
    v_mfma_f32_16x16x32_bf16 v[40:43], v[116:119], v[216:219], v[40:43]
    s_waitcnt vmcnt(1)
    s_xor_b32 s67, s67, 1
LC_poll1x:
    v_xor_b32 v240, s66, v233
    v_bitop3_b32 v240, v235, s66, v240 bitop3:0xbe
    v_bitop3_b32 v240, v237, s66, v240 bitop3:0xbe
    v_bitop3_b32 v240, v239, s66, v240 bitop3:0xbe
    v_or_b32 v240, s67, v240
    v_cmp_ne_u32 vcc, 0, v240
    s_cbranch_vccnz LC_poll1x_retry
LC_poll1x_ok:
    v_mfma_f32_16x16x32_bf16 v[36:39], v[88:91], v[220:223], v[36:39]
    v_lshlrev_b32_e64 v232, 16, v232
    v_lshlrev_b32_e64 v233, 16, v234
    v_mfma_f32_16x16x32_bf16 v[40:43], v[120:123], v[220:223], v[40:43]
    v_lshlrev_b32_e64 v236, 16, v236
    v_lshlrev_b32_e64 v237, 16, v238
    v_mfma_f32_16x16x32_bf16 v[36:39], v[92:95], v[224:227], v[36:39]
    ds_write_b64 v6, v[232:233] offset:0
    v_mfma_f32_16x16x32_bf16 v[40:43], v[124:127], v[224:227], v[40:43]
    ds_write_b64 v6, v[236:237] offset:128
    s_waitcnt lgkmcnt(2)
    v_mfma_f32_16x16x32_bf16 v[36:39], v[64:67], v[196:199], v[36:39]
    ds_read_b128 v[216:219], v2 offset:2880
    ds_read_b128 v[220:223], v2 offset:2944
    v_mfma_f32_16x16x32_bf16 v[40:43], v[96:99], v[196:199], v[40:43]
    ds_read_b128 v[224:227], v2 offset:3008
    v_mfma_f32_16x16x32_bf16 v[44:47], v[128:131], v[196:199], 0
    v_mfma_f32_16x16x32_bf16 v[52:55], v[28:31], v[196:199], 0
    v_mfma_f32_16x16x32_bf16 v[40:43], v[172:175], v[132:135], v[40:43]
    v_mfma_f32_16x16x32_bf16 v[40:43], v[180:183], v[144:147], v[40:43]
    s_mov_b64 exec, s[70:71]
    global_load_dword v10, v246, s[38:39]
    s_mov_b64 exec, -1
    v_mfma_f32_16x16x32_bf16 v[44:47], v[172:175], v[136:139], v[44:47]
    v_mfma_f32_16x16x32_bf16 v[44:47], v[180:183], v[148:151], v[44:47]
    s_waitcnt lgkmcnt(0)
    s_barrier
    v_mfma_f32_16x16x32_bf16 v[48:51], v[172:175], v[140:143], v[48:51]
    ds_read_b64 v[232:233], v3 offset:3608
    ds_read_b128 v[236:239], v4 offset:0
    v_mfma_f32_16x16x32_bf16 v[48:51], v[180:183], v[152:155], v[48:51]
    v_mfma_f32_16x16x32_bf16 v[48:51], v[188:191], v[156:159], v[48:51]
    v_mfma_f32_16x16x32_bf16 v[52:55], v[188:191], v[160:163], v[52:55]
    v_mfma_f32_16x16x32_bf16 v[56:59], v[188:191], v[164:167], 0
    s_waitcnt lgkmcnt(0)
    v_and_b32 v240, 0xffff0000, v233
    v_mfma_f32_16x16x32_bf16 v[60:63], v[188:191], v[168:171], 0
    v_lshlrev_b32_e64 v241, 16, v233
    v_and_b32 v242, 0xffff0000, v232
    v_mfma_f32_16x16x32_bf16 v[172:175], v[196:199], v[12:15], 0
    v_lshlrev_b32_e64 v243, 16, v232
    v_sub_f32_e64 v32, v32, v240
    v_mfma_f32_16x16x32_bf16 v[176:179], v[196:199], v[16:19], 0
    v_sub_f32_e64 v33, v33, v241
    v_sub_f32_e64 v34, v34, v242
    v_mfma_f32_16x16x32_bf16 v[188:191], v[196:199], v[20:23], 0
    v_sub_f32_e64 v35, v35, v243
    v_fma_f32 v32, v236, v32, v240
    v_mfma_f32_16x16x32_bf16 v[180:183], v[228:231], v[12:15], 0
    v_fma_f32 v33, v237, v33, v241
    v_fma_f32 v34, v238, v34, v242
    v_mfma_f32_16x16x32_bf16 v[184:187], v[228:231], v[16:19], 0
    v_fma_f32 v35, v239, v35, v243
    v_cvt_pk_bf16_f32 v234, v32, v33
    v_mfma_f32_16x16x32_bf16 v[192:195], v[228:231], v[24:27], 0
    ds_read_b64 v[232:233], v3 offset:3096
    v_cvt_pk_bf16_f32 v235, v34, v35
    v_mfma_f32_16x16x32_bf16 v[40:43], v[68:71], v[200:203], v[40:43]
    ds_read_b128 v[236:239], v4 offset:1024
    v_cvt_pk_bf16_f32 v172, v172, v176
    v_mfma_f32_16x16x32_bf16 v[44:47], v[100:103], v[200:203], v[44:47]
    ds_write_b64 v5, v[234:235] offset:0
    v_mfma_f32_16x16x32_bf16 v[40:43], v[72:75], v[204:207], v[40:43]
    ds_read_b128 v[196:199], v2 offset:2560
    v_cvt_pk_bf16_f32 v173, v173, v177
    v_mfma_f32_16x16x32_bf16 v[44:47], v[104:107], v[204:207], v[44:47]
    ds_read_b128 v[228:231], v2 offset:2576
    v_cvt_pk_bf16_f32 v174, v174, v178
    v_mfma_f32_16x16x32_bf16 v[40:43], v[76:79], v[208:211], v[40:43]
    s_waitcnt lgkmcnt(3)
    v_and_b32 v240, 0xffff0000, v233
    v_mfma_f32_16x16x32_bf16 v[44:47], v[108:111], v[208:211], v[44:47]
    v_lshlrev_b32_e64 v241, 16, v233
    v_and_b32 v242, 0xffff0000, v232
    v_mfma_f32_16x16x32_bf16 v[40:43], v[80:83], v[212:215], v[40:43]
    v_lshlrev_b32_e64 v243, 16, v232
    v_sub_f32_e64 v36, v36, v240
    v_mfma_f32_16x16x32_bf16 v[44:47], v[112:115], v[212:215], v[44:47]
    v_sub_f32_e64 v37, v37, v241
    v_sub_f32_e64 v38, v38, v242
    v_mfma_f32_16x16x32_bf16 v[40:43], v[84:87], v[216:219], v[40:43]
    v_sub_f32_e64 v39, v39, v243
    v_fma_f32 v36, v236, v36, v240
    v_mfma_f32_16x16x32_bf16 v[44:47], v[116:119], v[216:219], v[44:47]
    v_fma_f32 v37, v237, v37, v241
    v_fma_f32 v38, v238, v38, v242
    v_mfma_f32_16x16x32_bf16 v[40:43], v[88:91], v[220:223], v[40:43]
    v_fma_f32 v39, v239, v39, v243
    v_cvt_pk_bf16_f32 v234, v36, v37
    v_mfma_f32_16x16x32_bf16 v[44:47], v[120:123], v[220:223], v[44:47]
    v_cvt_pk_bf16_f32 v235, v38, v39
    v_cvt_pk_bf16_f32 v175, v175, v179
    v_mfma_f32_16x16x32_bf16 v[40:43], v[92:95], v[224:227], v[40:43]
    ds_write_b64 v5, v[234:235] offset:576
    v_mfma_f32_16x16x32_bf16 v[44:47], v[124:127], v[224:227], v[44:47]
    v_cvt_pk_bf16_f32 v180, v180, v184
    s_waitcnt lgkmcnt(1)
    v_mfma_f32_16x16x32_bf16 v[40:43], v[64:67], v[196:199], v[40:43]
    ds_read_b64 v[232:233], v3 offset:2584
    v_cvt_pk_bf16_f32 v181, v181, v185
    v_mfma_f32_16x16x32_bf16 v[44:47], v[96:99], v[196:199], v[44:47]
    ds_read_b128 v[236:239], v4 offset:2048
    v_cvt_pk_bf16_f32 v182, v182, v186
    v_mfma_f32_16x16x32_bf16 v[48:51], v[128:131], v[196:199], v[48:51]
    ds_read_b128 v[200:203], v2 offset:2112
    v_cvt_pk_bf16_f32 v183, v183, v187
    v_mfma_f32_16x16x32_bf16 v[56:59], v[28:31], v[196:199], v[56:59]
    ds_read_b128 v[204:207], v2 offset:2176
    v_cvt_pk_bf16_f32 v188, v188, v192
    v_mfma_f32_16x16x32_bf16 v[44:47], v[172:175], v[132:135], v[44:47]
    ds_read_b128 v[208:211], v2 offset:2240
    v_cvt_pk_bf16_f32 v189, v189, v193
    v_mfma_f32_16x16x32_bf16 v[44:47], v[180:183], v[144:147], v[44:47]
    ds_read_b128 v[212:215], v2 offset:2304
    v_cvt_pk_bf16_f32 v190, v190, v194
    v_mfma_f32_16x16x32_bf16 v[48:51], v[172:175], v[136:139], v[48:51]
    v_cvt_pk_bf16_f32 v191, v191, v195
    v_mfma_f32_16x16x32_bf16 v[48:51], v[180:183], v[148:151], v[48:51]
    ds_read_b128 v[216:219], v2 offset:2368
    ds_read_b128 v[220:223], v2 offset:2432
    v_mfma_f32_16x16x32_bf16 v[52:55], v[172:175], v[140:143], v[52:55]
    ds_read_b128 v[224:227], v2 offset:2496
    v_mfma_f32_16x16x32_bf16 v[52:55], v[180:183], v[152:155], v[52:55]
    s_waitcnt lgkmcnt(3)
    v_and_b32 v240, 0xffff0000, v233
    v_mfma_f32_16x16x32_bf16 v[52:55], v[188:191], v[156:159], v[52:55]
    v_lshlrev_b32_e64 v241, 16, v233
    v_and_b32 v242, 0xffff0000, v232
    v_mfma_f32_16x16x32_bf16 v[56:59], v[188:191], v[160:163], v[56:59]
    s_barrier
    ds_read_b64_tr_b16 v[244:245], v8 offset:0
    v_mfma_f32_16x16x32_bf16 v[60:63], v[188:191], v[164:167], v[60:63]
    ds_read_b64_tr_b16 v[246:247], v9 offset:0
    s_waitcnt vmcnt(1)
    v_mfma_f32_16x16x32_bf16 v[172:175], v[196:199], v[12:15], 0
    v_lshlrev_b32_e64 v243, 16, v232
    v_sub_f32_e64 v40, v40, v240
    v_mfma_f32_16x16x32_bf16 v[176:179], v[196:199], v[16:19], 0
    v_sub_f32_e64 v41, v41, v241
    v_sub_f32_e64 v42, v42, v242
    v_mfma_f32_16x16x32_bf16 v[188:191], v[196:199], v[20:23], 0
    ds_read_b128 v[196:199], v2 offset:2048
    v_sub_f32_e64 v43, v43, v243
    v_mfma_f32_16x16x32_bf16 v[180:183], v[228:231], v[12:15], 0
    s_waitcnt lgkmcnt(1)
    buffer_store_dwordx4 v[244:247], v11, s[52:55], s60 offen
    v_mfma_f32_16x16x32_bf16 v[184:187], v[228:231], v[16:19], 0
    v_fma_f32 v40, v236, v40, v240
    v_fma_f32 v41, v237, v41, v241
    v_mfma_f32_16x16x32_bf16 v[192:195], v[228:231], v[24:27], 0
    v_fma_f32 v42, v238, v42, v242
    v_fma_f32 v43, v239, v43, v243
    v_mfma_f32_16x16x32_bf16 v[44:47], v[68:71], v[200:203], v[44:47]
    v_cvt_pk_bf16_f32 v234, v40, v41
    v_cvt_pk_bf16_f32 v235, v42, v43
    v_mfma_f32_16x16x32_bf16 v[48:51], v[100:103], v[200:203], v[48:51]
    ds_write_b64 v5, v[234:235] offset:1152
    v_mfma_f32_16x16x32_bf16 v[44:47], v[72:75], v[204:207], v[44:47]
    ds_read_b128 v[228:231], v2 offset:2064
    v_perm_b32 v244, v248, v252, s64
    v_mfma_f32_16x16x32_bf16 v[48:51], v[104:107], v[204:207], v[48:51]
    ds_write_addtid_b32 v244 offset:0
    v_perm_b32 v245, v248, v252, s65
    v_mfma_f32_16x16x32_bf16 v[44:47], v[76:79], v[208:211], v[44:47]
    ds_write_addtid_b32 v245 offset:19008
    v_cvt_pk_bf16_f32 v172, v172, v176
    v_mfma_f32_16x16x32_bf16 v[48:51], v[108:111], v[208:211], v[48:51]
    v_cvt_pk_bf16_f32 v173, v173, v177
    v_cvt_pk_bf16_f32 v174, v174, v178
    v_mfma_f32_16x16x32_bf16 v[44:47], v[80:83], v[212:215], v[44:47]
    v_cvt_pk_bf16_f32 v175, v175, v179
    v_perm_b32 v246, v249, v253, s64
    v_mfma_f32_16x16x32_bf16 v[48:51], v[112:115], v[212:215], v[48:51]
    ds_write_addtid_b32 v246 offset:38016
    v_perm_b32 v247, v249, v253, s65
    v_mfma_f32_16x16x32_bf16 v[44:47], v[84:87], v[216:219], v[44:47]
    ds_write_addtid_b32 v247 offset:57024
    v_cvt_pk_bf16_f32 v180, v180, v184
    v_mfma_f32_16x16x32_bf16 v[48:51], v[116:119], v[216:219], v[48:51]
    v_cvt_pk_bf16_f32 v181, v181, v185
    v_cvt_pk_bf16_f32 v182, v182, v186
    v_mfma_f32_16x16x32_bf16 v[44:47], v[88:91], v[220:223], v[44:47]
    v_cvt_pk_bf16_f32 v183, v183, v187
    v_perm_b32 v244, v250, v254, s64
    v_mfma_f32_16x16x32_bf16 v[48:51], v[120:123], v[220:223], v[48:51]
    v_perm_b32 v245, v250, v254, s65
    v_perm_b32 v246, v251, v255, s64
    v_mfma_f32_16x16x32_bf16 v[44:47], v[92:95], v[224:227], v[44:47]
    v_perm_b32 v247, v251, v255, s65
    v_cvt_pk_bf16_f32 v188, v188, v192
    v_mfma_f32_16x16x32_bf16 v[48:51], v[124:127], v[224:227], v[48:51]
    ds_read_b64 v[248:249], v3 offset:2072
    s_waitcnt lgkmcnt(1)
    v_mfma_f32_16x16x32_bf16 v[44:47], v[64:67], v[196:199], v[44:47]
    ds_read_b128 v[252:255], v4 offset:3072
    s_mov_b32 m0, s69
    v_mfma_f32_16x16x32_bf16 v[48:51], v[96:99], v[196:199], v[48:51]
    ds_write_addtid_b32 v244 offset:0
    v_cvt_pk_bf16_f32 v189, v189, v193
    v_mfma_f32_16x16x32_bf16 v[52:55], v[128:131], v[196:199], v[52:55]
    ds_write_addtid_b32 v245 offset:19008
    v_cvt_pk_bf16_f32 v190, v190, v194
    v_mfma_f32_16x16x32_bf16 v[60:63], v[28:31], v[196:199], v[60:63]
    ds_write_addtid_b32 v246 offset:38016
    v_cvt_pk_bf16_f32 v191, v191, v195
    v_mfma_f32_16x16x32_bf16 v[48:51], v[172:175], v[132:135], v[48:51]
    ds_write_addtid_b32 v247 offset:57024
    v_mfma_f32_16x16x32_bf16 v[48:51], v[180:183], v[144:147], v[48:51]
    s_waitcnt lgkmcnt(3)
    v_and_b32 v240, 0xffff0000, v249
    v_mfma_f32_16x16x32_bf16 v[52:55], v[172:175], v[136:139], v[52:55]
    v_lshlrev_b32_e64 v241, 16, v249
    v_and_b32 v242, 0xffff0000, v248
    v_mfma_f32_16x16x32_bf16 v[52:55], v[180:183], v[148:151], v[52:55]
    v_lshlrev_b32_e64 v243, 16, v248
    v_sub_f32_e64 v44, v44, v240
    v_mfma_f32_16x16x32_bf16 v[56:59], v[172:175], v[140:143], v[56:59]
    s_waitcnt lgkmcnt(0)
    s_barrier
    v_mfma_f32_16x16x32_bf16 v[56:59], v[180:183], v[152:155], v[56:59]
    ds_read_b128 v[200:203], v2 offset:1600
    v_sub_f32_e64 v45, v45, v241
    v_mfma_f32_16x16x32_bf16 v[56:59], v[188:191], v[156:159], v[56:59]
    ds_read_b128 v[204:207], v2 offset:1664
    v_sub_f32_e64 v46, v46, v242
    v_mfma_f32_16x16x32_bf16 v[60:63], v[188:191], v[160:163], v[60:63]
    ds_read_b128 v[208:211], v2 offset:1728
    v_sub_f32_e64 v47, v47, v243
    v_mfma_f32_16x16x32_bf16 v[172:175], v[196:199], v[12:15], 0
    ds_read_b128 v[212:215], v2 offset:1792
    v_fma_f32 v44, v252, v44, v240
    v_mfma_f32_16x16x32_bf16 v[176:179], v[196:199], v[16:19], 0
    ds_read_b128 v[216:219], v2 offset:1856
    v_fma_f32 v45, v253, v45, v241
    v_mfma_f32_16x16x32_bf16 v[188:191], v[196:199], v[20:23], 0
    ds_read_b128 v[220:223], v2 offset:1920
    v_fma_f32 v46, v254, v46, v242
    v_mfma_f32_16x16x32_bf16 v[180:183], v[228:231], v[12:15], 0
    ds_read_b128 v[224:227], v2 offset:1984
    v_fma_f32 v47, v255, v47, v243
    v_mfma_f32_16x16x32_bf16 v[184:187], v[228:231], v[16:19], 0
    ds_read_b128 v[196:199], v2 offset:1536
    v_cvt_pk_bf16_f32 v250, v44, v45
    v_mfma_f32_16x16x32_bf16 v[192:195], v[228:231], v[24:27], 0
    v_cvt_pk_bf16_f32 v251, v46, v47
    s_waitcnt lgkmcnt(3)
    v_mfma_f32_16x16x32_bf16 v[48:51], v[68:71], v[200:203], v[48:51]
    ds_write_b64 v5, v[250:251] offset:1728
    v_mfma_f32_16x16x32_bf16 v[52:55], v[100:103], v[200:203], v[52:55]
    ds_read_b64 v[232:233], v3 offset:1560
    v_cvt_pk_bf16_f32 v172, v172, v176
    v_mfma_f32_16x16x32_bf16 v[48:51], v[72:75], v[204:207], v[48:51]
    ds_read_b128 v[236:239], v4 offset:4096
    v_cvt_pk_bf16_f32 v173, v173, v177
    v_mfma_f32_16x16x32_bf16 v[52:55], v[104:107], v[204:207], v[52:55]
    ds_read_b128 v[228:231], v2 offset:1552
    v_cvt_pk_bf16_f32 v174, v174, v178
    v_mfma_f32_16x16x32_bf16 v[48:51], v[76:79], v[208:211], v[48:51]
    s_waitcnt lgkmcnt(3)
    s_barrier
    v_mfma_f32_16x16x32_bf16 v[52:55], v[108:111], v[208:211], v[52:55]
    ds_read_b64_tr_b16 v[244:245], v8 offset:1152
    v_cvt_pk_bf16_f32 v175, v175, v179
    v_mfma_f32_16x16x32_bf16 v[48:51], v[80:83], v[212:215], v[48:51]
    ds_read_b64_tr_b16 v[246:247], v9 offset:1152
    v_cvt_pk_bf16_f32 v180, v180, v184
    v_mfma_f32_16x16x32_bf16 v[52:55], v[112:115], v[212:215], v[52:55]
    ds_read_b128 v[200:203], v2 offset:1088
    v_cvt_pk_bf16_f32 v181, v181, v185
    v_mfma_f32_16x16x32_bf16 v[48:51], v[84:87], v[216:219], v[48:51]
    ds_read_b128 v[204:207], v2 offset:1152
    v_cvt_pk_bf16_f32 v182, v182, v186
    v_mfma_f32_16x16x32_bf16 v[52:55], v[116:119], v[216:219], v[52:55]
    ds_read_b128 v[208:211], v2 offset:1216
    v_cvt_pk_bf16_f32 v183, v183, v187
    v_mfma_f32_16x16x32_bf16 v[48:51], v[88:91], v[220:223], v[48:51]
    s_waitcnt lgkmcnt(3)
    buffer_store_dwordx4 v[244:247], v11, s[52:55], s9 offen
    v_mfma_f32_16x16x32_bf16 v[52:55], v[120:123], v[220:223], v[52:55]
    ds_read_b128 v[212:215], v2 offset:1280
    v_cvt_pk_bf16_f32 v188, v188, v192
    v_mfma_f32_16x16x32_bf16 v[48:51], v[92:95], v[224:227], v[48:51]
    ds_read_b128 v[216:219], v2 offset:1344
    v_cvt_pk_bf16_f32 v189, v189, v193
    v_mfma_f32_16x16x32_bf16 v[52:55], v[124:127], v[224:227], v[52:55]
    ds_read_b128 v[220:223], v2 offset:1408
    v_cvt_pk_bf16_f32 v190, v190, v194
    v_mfma_f32_16x16x32_bf16 v[48:51], v[64:67], v[196:199], v[48:51]
    ds_read_b128 v[224:227], v2 offset:1472
    v_cvt_pk_bf16_f32 v191, v191, v195
    v_mfma_f32_16x16x32_bf16 v[52:55], v[96:99], v[196:199], v[52:55]
    v_and_b32 v240, 0xffff0000, v233
    v_lshlrev_b32_e64 v241, 16, v233
    v_mfma_f32_16x16x32_bf16 v[56:59], v[128:131], v[196:199], v[56:59]
    v_and_b32 v242, 0xffff0000, v232
    v_lshlrev_b32_e64 v243, 16, v232
    v_mfma_f32_16x16x32_bf16 v[52:55], v[172:175], v[132:135], v[52:55]
    v_sub_f32_e64 v48, v48, v240
    v_sub_f32_e64 v49, v49, v241
    v_mfma_f32_16x16x32_bf16 v[52:55], v[180:183], v[144:147], v[52:55]
    v_sub_f32_e64 v50, v50, v242
    v_sub_f32_e64 v51, v51, v243
    v_mfma_f32_16x16x32_bf16 v[56:59], v[172:175], v[136:139], v[56:59]
    ds_read_b64 v[248:249], v3 offset:1048
    v_fma_f32 v48, v236, v48, v240
    v_mfma_f32_16x16x32_bf16 v[56:59], v[180:183], v[148:151], v[56:59]
    ds_read_b128 v[252:255], v4 offset:5120
    v_fma_f32 v49, v237, v49, v241
    v_mfma_f32_16x16x32_bf16 v[60:63], v[172:175], v[140:143], v[60:63]
    v_fma_f32 v50, v238, v50, v242
    v_fma_f32 v51, v239, v51, v243
    v_mfma_f32_16x16x32_bf16 v[60:63], v[180:183], v[152:155], v[60:63]
    v_cvt_pk_bf16_f32 v234, v48, v49
    v_cvt_pk_bf16_f32 v235, v50, v51
    v_mfma_f32_16x16x32_bf16 v[60:63], v[188:191], v[156:159], v[60:63]
    ds_write_b64 v5, v[234:235] offset:2304
    v_mfma_f32_16x16x32_bf16 v[172:175], v[196:199], v[12:15], 0
    v_and_b32_e64 v6, 7, v1
    v_lshl_add_u32 v6, v6, 7, s29
    v_mfma_f32_16x16x32_bf16 v[176:179], v[196:199], v[16:19], 0
    ds_read_b128 v[196:199], v2 offset:1024
    ds_read_b64 v[232:233], v3 offset:536
    v_mfma_f32_16x16x32_bf16 v[180:183], v[228:231], v[12:15], 0
    ds_read_b128 v[236:239], v4 offset:6144
    v_mfma_f32_16x16x32_bf16 v[184:187], v[228:231], v[16:19], 0
    s_waitcnt lgkmcnt(3)
    s_barrier
    v_mfma_f32_16x16x32_bf16 v[52:55], v[68:71], v[200:203], v[52:55]
    ds_read_b64_tr_b16 v[244:245], v8 offset:2304
    v_cvt_pk_bf16_f32 v172, v172, v176
    v_mfma_f32_16x16x32_bf16 v[52:55], v[72:75], v[204:207], v[52:55]
    ds_read_b64_tr_b16 v[246:247], v9 offset:2304
    v_cvt_pk_bf16_f32 v173, v173, v177
    v_mfma_f32_16x16x32_bf16 v[52:55], v[76:79], v[208:211], v[52:55]
    ds_read_b128 v[228:231], v2 offset:1040
    v_cvt_pk_bf16_f32 v174, v174, v178
    v_mfma_f32_16x16x32_bf16 v[52:55], v[80:83], v[212:215], v[52:55]
    v_cvt_pk_bf16_f32 v175, v175, v179
    v_cvt_pk_bf16_f32 v180, v180, v184
    v_mfma_f32_16x16x32_bf16 v[52:55], v[84:87], v[216:219], v[52:55]
    v_cvt_pk_bf16_f32 v181, v181, v185
    v_cvt_pk_bf16_f32 v182, v182, v186
    v_mfma_f32_16x16x32_bf16 v[52:55], v[88:91], v[220:223], v[52:55]
    s_waitcnt lgkmcnt(1)
    buffer_store_dwordx4 v[244:247], v11, s[52:55], s8 offen
    v_mfma_f32_16x16x32_bf16 v[52:55], v[92:95], v[224:227], v[52:55]
    v_cvt_pk_bf16_f32 v183, v183, v187
    v_and_b32 v20, 0xffff0000, v249
    v_mfma_f32_16x16x32_bf16 v[52:55], v[64:67], v[196:199], v[52:55]
    v_lshlrev_b32_e64 v21, 16, v249
    v_and_b32 v22, 0xffff0000, v248
    v_mfma_f32_16x16x32_bf16 v[56:59], v[100:103], v[200:203], v[56:59]
    ds_read_b128 v[200:203], v2 offset:576
    v_lshlrev_b32_e64 v23, 16, v248
    v_mfma_f32_16x16x32_bf16 v[56:59], v[104:107], v[204:207], v[56:59]
    ds_read_b128 v[204:207], v2 offset:640
    v_and_b32 v240, 0xffff0000, v233
    v_mfma_f32_16x16x32_bf16 v[56:59], v[108:111], v[208:211], v[56:59]
    ds_read_b128 v[208:211], v2 offset:704
    v_sub_f32_e64 v52, v52, v20
    v_mfma_f32_16x16x32_bf16 v[56:59], v[112:115], v[212:215], v[56:59]
    ds_read_b128 v[212:215], v2 offset:768
    v_sub_f32_e64 v53, v53, v21
    v_mfma_f32_16x16x32_bf16 v[56:59], v[116:119], v[216:219], v[56:59]
    ds_read_b128 v[216:219], v2 offset:832
    v_sub_f32_e64 v54, v54, v22
    v_mfma_f32_16x16x32_bf16 v[56:59], v[120:123], v[220:223], v[56:59]
    ds_read_b128 v[220:223], v2 offset:896
    v_sub_f32_e64 v55, v55, v23
    v_mfma_f32_16x16x32_bf16 v[56:59], v[124:127], v[224:227], v[56:59]
    ds_read_b128 v[224:227], v2 offset:960
    v_fma_f32 v52, v252, v52, v20
    v_mfma_f32_16x16x32_bf16 v[56:59], v[96:99], v[196:199], v[56:59]
    v_fma_f32 v53, v253, v53, v21
    v_fma_f32 v54, v254, v54, v22
    v_mfma_f32_16x16x32_bf16 v[60:63], v[128:131], v[196:199], v[60:63]
    v_fma_f32 v55, v255, v55, v23
    v_cvt_pk_bf16_f32 v250, v52, v53
    v_mfma_f32_16x16x32_bf16 v[56:59], v[172:175], v[132:135], v[56:59]
    v_cvt_pk_bf16_f32 v251, v54, v55
    v_lshlrev_b32_e64 v241, 16, v233
    v_mfma_f32_16x16x32_bf16 v[56:59], v[180:183], v[144:147], v[56:59]
    ds_write_b64 v5, v[250:251] offset:2880
    v_mfma_f32_16x16x32_bf16 v[60:63], v[172:175], v[136:139], v[60:63]
    v_and_b32 v242, 0xffff0000, v232
    v_lshlrev_b32_e64 v243, 16, v232
    v_mfma_f32_16x16x32_bf16 v[60:63], v[180:183], v[148:151], v[60:63]
    ds_read_b64 v[248:249], v3 offset:24
    ds_read_b128 v[252:255], v4 offset:7168
    v_mfma_f32_16x16x32_bf16 v[172:175], v[196:199], v[12:15], 0
    v_mfma_f32_16x16x32_bf16 v[176:179], v[196:199], v[16:19], 0
    ds_read_b128 v[196:199], v2 offset:512
    s_waitcnt lgkmcnt(3)
    v_mfma_f32_16x16x32_bf16 v[180:183], v[228:231], v[12:15], 0
    s_barrier
    s_setprio 1
    v_mfma_f32_16x16x32_bf16 v[184:187], v[228:231], v[16:19], 0
    s_waitcnt lgkmcnt(1)
    v_and_b32 v20, 0xffff0000, v249
    v_mfma_f32_16x16x32_bf16 v[56:59], v[68:71], v[200:203], v[56:59]
    v_cvt_pk_bf16_f32 v172, v172, v176
    v_cvt_pk_bf16_f32 v173, v173, v177
    v_mfma_f32_16x16x32_bf16 v[56:59], v[72:75], v[204:207], v[56:59]
    global_load_dword v10, v6, s[46:47] sc1
    v_mfma_f32_16x16x32_bf16 v[56:59], v[76:79], v[208:211], v[56:59]
    v_cvt_pk_bf16_f32 v174, v174, v178
    v_cvt_pk_bf16_f32 v175, v175, v179
    v_mfma_f32_16x16x32_bf16 v[56:59], v[80:83], v[212:215], v[56:59]
    v_cvt_pk_bf16_f32 v180, v180, v184
    v_cvt_pk_bf16_f32 v181, v181, v185
    v_mfma_f32_16x16x32_bf16 v[56:59], v[84:87], v[216:219], v[56:59]
    v_cvt_pk_bf16_f32 v182, v182, v186
    v_cvt_pk_bf16_f32 v183, v183, v187
    v_mfma_f32_16x16x32_bf16 v[56:59], v[88:91], v[220:223], v[56:59]
    v_lshlrev_b32_e64 v21, 16, v249
    v_and_b32 v22, 0xffff0000, v248
    v_mfma_f32_16x16x32_bf16 v[56:59], v[92:95], v[224:227], v[56:59]
    v_lshlrev_b32_e64 v23, 16, v248
    s_waitcnt lgkmcnt(0)
    v_mfma_f32_16x16x32_bf16 v[56:59], v[64:67], v[196:199], v[56:59]
    v_mfma_f32_16x16x32_bf16 v[60:63], v[100:103], v[200:203], v[60:63]
    ds_read_b128 v[200:203], v2 offset:64
    v_mfma_f32_16x16x32_bf16 v[60:63], v[104:107], v[204:207], v[60:63]
    ds_read_b128 v[204:207], v2 offset:128
    v_mfma_f32_16x16x32_bf16 v[60:63], v[108:111], v[208:211], v[60:63]
    ds_read_b128 v[208:211], v2 offset:192
    v_mfma_f32_16x16x32_bf16 v[60:63], v[112:115], v[212:215], v[60:63]
    ds_read_b128 v[212:215], v2 offset:256
    v_sub_f32_e64 v56, v56, v240
    v_sub_f32_e64 v57, v57, v241
    v_sub_f32_e64 v58, v58, v242
    v_sub_f32_e64 v59, v59, v243
    v_fma_f32 v56, v236, v56, v240
    v_fma_f32 v57, v237, v57, v241
    v_fma_f32 v58, v238, v58, v242
    v_fma_f32 v59, v239, v59, v243
    v_cvt_pk_bf16_f32 v234, v56, v57
    v_cvt_pk_bf16_f32 v235, v58, v59
    v_mfma_f32_16x16x32_bf16 v[60:63], v[116:119], v[216:219], v[60:63]
    ds_write_b64 v5, v[234:235] offset:3456
    v_mfma_f32_16x16x32_bf16 v[60:63], v[120:123], v[220:223], v[60:63]
    s_setprio 0
    ds_read_b128 v[216:219], v2 offset:320
    ds_read_b128 v[220:223], v2 offset:384
    v_mfma_f32_16x16x32_bf16 v[60:63], v[124:127], v[224:227], v[60:63]
    ds_read_b128 v[224:227], v2 offset:448
    v_mfma_f32_16x16x32_bf16 v[60:63], v[96:99], v[196:199], v[60:63]
    ds_read_b128 v[196:199], v2 offset:0
    v_mfma_f32_16x16x32_bf16 v[60:63], v[172:175], v[132:135], v[60:63]
    s_waitcnt vmcnt(0)
    v_cmp_ne_u32 vcc, s66, v10
    s_cbranch_vccnz LC_nogatx
    global_load_dwordx4 v[156:159], v7, s[46:47] offset:0 sc1
    global_load_dwordx4 v[160:163], v7, s[46:47] offset:1024 sc1
LC_gat1x:
    v_mfma_f32_16x16x32_bf16 v[60:63], v[180:183], v[144:147], v[60:63]
    s_waitcnt lgkmcnt(2)
    v_mfma_f32_16x16x32_bf16 v[60:63], v[68:71], v[200:203], v[60:63]
    v_mfma_f32_16x16x32_bf16 v[60:63], v[72:75], v[204:207], v[60:63]
    s_barrier
    ds_read_b64_tr_b16 v[244:245], v8 offset:3456
    v_mfma_f32_16x16x32_bf16 v[60:63], v[76:79], v[208:211], v[60:63]
    ds_read_b64_tr_b16 v[246:247], v9 offset:3456
    v_mfma_f32_16x16x32_bf16 v[60:63], v[80:83], v[212:215], v[60:63]
    v_mfma_f32_16x16x32_bf16 v[60:63], v[84:87], v[216:219], v[60:63]
    v_mfma_f32_16x16x32_bf16 v[60:63], v[88:91], v[220:223], v[60:63]
    s_waitcnt lgkmcnt(1)
    v_mfma_f32_16x16x32_bf16 v[60:63], v[92:95], v[224:227], v[60:63]
    s_waitcnt lgkmcnt(0)
    buffer_store_dwordx4 v[244:247], v11, s[52:55], s62 offen
    v_mfma_f32_16x16x32_bf16 v[60:63], v[64:67], v[196:199], v[60:63]
    s_nop 7
    v_sub_f32_e64 v60, v60, v20
    v_sub_f32_e64 v61, v61, v21
    v_sub_f32_e64 v62, v62, v22
    v_sub_f32_e64 v63, v63, v23
    v_fma_f32 v60, v252, v60, v20
    v_fma_f32 v61, v253, v61, v21
    v_fma_f32 v62, v254, v62, v22
    v_fma_f32 v63, v255, v63, v23
    v_cvt_pk_bf16_f32 v250, v60, v61
    v_cvt_pk_bf16_f32 v251, v62, v63
    ds_write_b64 v5, v[250:251] offset:4032
    s_cbranch_vccnz LC_chk2x
LC_gat2x:
    s_waitcnt lgkmcnt(0)
    s_barrier
    s_cbranch_vccnz LC_late
    s_cmp_eq_u32 s28, 1
    s_cbranch_scc1 LC_w2x
    s_waitcnt vmcnt(1)
    s_branch LC_final
LC_path2:
    ds_read_b128 v[132:135], v49 offset:0
    ds_read_b128 v[136:139], v49 offset:32
    ds_read_b128 v[140:143], v49 offset:64
    ds_read_b128 v[144:147], v49 offset:96
    ds_read_b128 v[148:151], v49 offset:128
    ds_read_b128 v[152:155], v49 offset:160
    s_waitcnt lgkmcnt(5)
    v_mfma_f32_32x32x16_bf16 v[32:47], v[132:135], v[64:67], 0
    ds_read_b128 v[156:159], v49 offset:192
    ds_read_b128 v[160:163], v49 offset:224
    v_lshlrev_b32 v58, 5, v59
    v_sub_u32 v3, s18, v58
    s_waitcnt lgkmcnt(6)
    v_mfma_f32_32x32x16_bf16 v[32:47], v[136:139], v[68:71], v[32:47]
    ds_read_b128 v[164:167], v49 offset:256
    ds_read_b128 v[168:171], v49 offset:288
    v_lshl_add_u32 v2, v7, 4, v3
    v_lshlrev_b32 v5, 3, v7
    s_waitcnt lgkmcnt(7)
    v_mfma_f32_32x32x16_bf16 v[32:47], v[140:143], v[72:75], v[32:47]
    ds_read_b128 v[172:175], v49 offset:320
    ds_read_b128 v[176:179], v49 offset:352
    v_sub_u32 v3, v3, v5
    v_mul_u32_u24 v5, 144, v7
    s_waitcnt lgkmcnt(8)
    v_mfma_f32_32x32x16_bf16 v[32:47], v[144:147], v[76:79], v[32:47]
    ds_read_b128 v[180:183], v49 offset:384
    ds_read_b128 v[184:187], v49 offset:416
    v_lshl_add_u32 v58, v59, 3, s61
    v_add_u32 v5, v5, v58
    s_waitcnt lgkmcnt(9)
    v_mfma_f32_32x32x16_bf16 v[32:47], v[148:151], v[80:83], v[32:47]
    ds_read_b128 v[188:191], v49 offset:448
    ds_read_b128 v[192:195], v49 offset:480
    v_lshl_add_u32 v50, v56, 4, s61
    v_lshl_add_u32 v50, v57, 3, v50
    s_waitcnt lgkmcnt(10)
    v_mfma_f32_32x32x16_bf16 v[32:47], v[152:155], v[84:87], v[32:47]
    ds_write_addtid_b32 v54 offset:4608
    ds_write_addtid_b32 v54 offset:5664
    v_lshl_add_u32 v52, v56, 1, s61
    v_lshl_add_u32 v52, v57, 7, v52
    s_waitcnt lgkmcnt(11)
    v_mfma_f32_32x32x16_bf16 v[32:47], v[156:159], v[88:91], v[32:47]
    ds_write_addtid_b32 v54 offset:6896
    ds_write_addtid_b32 v54 offset:7152
    v_lshrrev_b32 v56, 1, v56
    v_lshl_add_u32 v51, v56, 2, s61
    s_waitcnt lgkmcnt(12)
    v_mfma_f32_32x32x16_bf16 v[32:47], v[160:163], v[92:95], v[32:47]
    v_lshl_add_u32 v51, v57, 6, v51
    v_add_u32 v56, 192, v51
    v_cndmask_b32 v51, v51, v56, s[14:15]
    v_and_b32 v56, 14, v1
    s_waitcnt lgkmcnt(4)
    v_mfma_f32_32x32x16_bf16 v[32:47], v[164:167], v[96:99], v[32:47]
    v_lshlrev_b32 v56, 1, v56
    v_lshl_add_u32 v56, v7, 4, v56
    v_mov_b32 v57, 5832
    v_mov_b32 v58, 4612
    v_cndmask_b32 v57, v57, v58, s[14:15]
    v_mfma_f32_32x32x16_bf16 v[32:47], v[168:171], v[100:103], v[32:47]
    v_add3_u32 v60, v56, v57, s61
    v_add_u32 v61, 1024, v60
    v_lshlrev_b32 v56, 4, v7
    v_lshl_add_u32 v62, v59, 2, s19
    v_sub_u32 v62, v62, v56
    v_mfma_f32_32x32x16_bf16 v[32:47], v[172:175], v[104:107], v[32:47]
    v_lshl_add_u32 v247, v1, 4, s20
    v_bfe_u32 v56, v1, 2, 2
    v_mul_u32_u24 v8, 19008, v56
    v_and_b32 v56, 3, v1
    v_mul_u32_u24 v56, 144, v56
    v_mfma_f32_32x32x16_bf16 v[32:47], v[176:179], v[108:111], v[32:47]
    v_lshl_add_u32 v57, v7, 3, s21
    v_add3_u32 v8, v8, v56, v57
    v_add_u32 v9, 76032, v8
    v_and_b32 v56, 1, v1
    v_lshl_add_u32 v6, v56, 3, s22
    v_mfma_f32_32x32x16_bf16 v[32:47], v[180:183], v[112:115], v[32:47]
    v_bfe_u32 v56, v1, 1, 2
    v_lshl_add_u32 v6, v56, 8, v6
    v_lshrrev_b32 v56, 3, v1
    v_lshl_add_u32 v6, v56, 4, v6
    v_lshl_add_u32 v246, v1, 7, s23
    v_mfma_f32_32x32x16_bf16 v[32:47], v[184:187], v[116:119], v[32:47]
    v_bfe_u32 v56, v1, 3, 1
    v_lshl_add_u32 v56, v56, 2, v7
    v_lshlrev_b32 v56, 3, v56
    v_add_u32 v56, 131072, v56
    v_lshl_add_u32 v7, v1, 4, s24
    v_mfma_f32_32x32x16_bf16 v[32:47], v[188:191], v[120:123], v[32:47]
    v_cndmask_b32 v7, v7, v56, s[30:31]
    v_mfma_f32_32x32x16_bf16 v[32:47], v[192:195], v[124:127], v[32:47]
    s_waitcnt vmcnt(0)
    v_perm_b32 v196, v232, v236, s64
    v_perm_b32 v197, v232, v236, s65
    v_perm_b32 v198, v233, v237, s64
    v_perm_b32 v199, v233, v237, s65
    v_perm_b32 v200, v234, v238, s64
    v_perm_b32 v201, v234, v238, s65
    v_perm_b32 v202, v235, v239, s64
    v_perm_b32 v203, v235, v239, s65
    s_mov_b32 m0, s68
    s_nop 0
    ds_write_addtid_b32 v196 offset:2048
    ds_write_addtid_b32 v197 offset:21056
    ds_write_addtid_b32 v198 offset:40064
    ds_write_addtid_b32 v199 offset:59072
    s_mov_b32 m0, s69
    s_nop 0
    ds_write_addtid_b32 v200 offset:2048
    ds_write_addtid_b32 v201 offset:21056
    ds_write_addtid_b32 v202 offset:40064
    ds_write_addtid_b32 v203 offset:59072
    s_setprio 0
    s_waitcnt lgkmcnt(0)
    s_barrier
    global_load_dwordx4 v[232:235], v247, s[46:47] offset:0 sc1
    global_load_dwordx4 v[236:239], v247, s[46:47] offset:1024 sc1
    v_add_f32 v32, v32, v55
    v_cvt_pk_bf16_f32 v65, v34, v35
    v_cvt_pk_bf16_f32 v64, v32, v33
    v_cvt_pk_bf16_f32 v66, v36, v36
    v_cvt_pk_bf16_f32 v67, v37, v38
    v_cvt_pk_bf16_f32 v68, v33, v34
    v_cvt_pk_bf16_f32 v69, v35, v39
    v_cvt_pk_bf16_f32 v70, v36, v37
    v_cvt_pk_bf16_f32 v71, v38, v38
    v_lshlrev_b32 v72, 16, v64
    v_mov_b32 v74, v71
    v_and_b32 v75, 0xffff, v71
    v_cvt_pk_bf16_f32 v58, v41, v41
    v_cvt_pk_bf16_f32 v56, v40, v41
    v_cvt_pk_bf16_f32 v57, v42, v43
    v_readlane_b32 s6, v58, 63
    ds_write_b64 v50, v[64:65] offset:4640
    ds_write_b64 v50, v[68:69] offset:5864
    ds_write_b64 v50, v[66:67] offset:5152
    ds_write_b64 v50, v[70:71] offset:6376
    ds_write_b32 v51, v56 offset:7024
    ds_write_b16 v52, v57 offset:7408
    ds_write_b16_d16_hi v52, v57 offset:7472
    s_mov_b64 exec, 1
    ds_write_b32 v50, v72 offset:5860
    s_mov_b32 exec_lo, 0
    s_mov_b32 exec_hi, 0x80000000
    ds_write_b64 v50, v[74:75] offset:5160
    ds_write_b32 v50, v74 offset:6384
    ds_write_b32 v50, v54 offset:6388
    s_mov_b64 exec, -1
    v_and_b32 v28, s6, v28
    v_and_b32 v29, s6, v29
    v_and_b32 v30, s6, v30
    v_and_b32 v31, s6, v31
    ds_read2_b32 v[68:69], v60 offset0:16 offset1:17
    ds_read2_b32 v[70:71], v60 offset0:18 offset1:19
    buffer_load_dwordx4 v[248:251], v0, s[48:51], s8 offen offset:0
    ds_read2_b32 v[100:101], v60 offset0:144 offset1:145
    ds_read2_b32 v[102:103], v60 offset0:146 offset1:147
    ds_read2_b32 v[72:73], v60 offset0:32 offset1:33
    ds_read2_b32 v[74:75], v60 offset0:34 offset1:35
    ds_read2_b32 v[104:105], v60 offset0:160 offset1:161
    ds_read2_b32 v[106:107], v60 offset0:162 offset1:163
    s_waitcnt vmcnt(1)
    s_xor_b32 s67, s67, 1
LC_poll1y:
    v_xor_b32 v240, s66, v233
    v_bitop3_b32 v240, v235, s66, v240 bitop3:0xbe
    v_bitop3_b32 v240, v237, s66, v240 bitop3:0xbe
    v_bitop3_b32 v240, v239, s66, v240 bitop3:0xbe
    v_or_b32 v240, s67, v240
    v_cmp_ne_u32 vcc, 0, v240
    s_cbranch_vccnz LC_poll1y_retry
LC_poll1y_ok:
    v_lshlrev_b32_e64 v232, 16, v232
    v_lshlrev_b32_e64 v233, 16, v234
    v_lshlrev_b32_e64 v236, 16, v236
    v_lshlrev_b32_e64 v237, 16, v238
    ds_write_b64 v6, v[232:233] offset:0
    ds_write_b64 v6, v[236:237] offset:128
    ds_read2_b32 v[76:77], v60 offset0:48 offset1:49
    ds_read2_b32 v[78:79], v60 offset0:50 offset1:51
    ds_read2_b32 v[108:109], v60 offset0:176 offset1:177
    ds_read2_b32 v[110:111], v60 offset0:178 offset1:179
    ds_read2_b32 v[80:81], v60 offset0:64 offset1:65
    ds_read2_b32 v[82:83], v60 offset0:66 offset1:67
    ds_read2_b32 v[112:113], v60 offset0:192 offset1:193
    ds_read2_b32 v[114:115], v60 offset0:194 offset1:195
    s_waitcnt lgkmcnt(8)
    s_barrier
    ds_read2_b32 v[84:85], v60 offset0:80 offset1:81
    ds_read2_b32 v[86:87], v60 offset0:82 offset1:83
    ds_read2_b32 v[116:117], v60 offset0:208 offset1:209
    ds_read2_b32 v[118:119], v60 offset0:210 offset1:211
    ds_read2_b32 v[88:89], v60 offset0:96 offset1:97
    ds_read2_b32 v[90:91], v60 offset0:98 offset1:99
    buffer_load_dwordx4 v[252:255], v0, s[48:51], s8 offen offset:2048
    ds_read2_b32 v[120:121], v60 offset0:224 offset1:225
    ds_read2_b32 v[122:123], v60 offset0:226 offset1:227
    ds_read2_b32 v[92:93], v60 offset0:112 offset1:113
    ds_read2_b32 v[94:95], v60 offset0:114 offset1:115
    ds_read2_b32 v[124:125], v60 offset0:240 offset1:241
    ds_read2_b32 v[126:127], v60 offset0:242 offset1:243
    ds_read2_b32 v[64:65], v60 offset0:0 offset1:1
    ds_read2_b32 v[66:67], v60 offset0:2 offset1:3
    ds_read2_b32 v[96:97], v60 offset0:128 offset1:129
    ds_read2_b32 v[98:99], v60 offset0:130 offset1:131
    ds_read2_b32 v[128:129], v61 offset0:0 offset1:1
    ds_read2_b32 v[130:131], v61 offset0:2 offset1:3
    ds_read_b128 v[200:203], v2 offset:3648
    ds_read_b128 v[204:207], v2 offset:3712
    ds_read_b128 v[208:211], v2 offset:3776
    ds_read_b128 v[212:215], v2 offset:3840
    ds_read_b128 v[216:219], v2 offset:3904
    ds_read_b128 v[220:223], v2 offset:3968
    ds_read_b128 v[224:227], v2 offset:4032
    ds_read_b128 v[196:199], v2 offset:3584
    ds_read_b128 v[228:231], v2 offset:3600
    s_waitcnt lgkmcnt(8)
    v_mfma_f32_16x16x32_bf16 v[32:35], v[68:71], v[200:203], 0
    ds_read_b64 v[232:233], v3 offset:3608
    ds_read_b128 v[236:239], v4 offset:0
    v_mfma_f32_16x16x32_bf16 v[36:39], v[100:103], v[200:203], 0
    ds_read_b128 v[200:203], v2 offset:3136
    s_waitcnt lgkmcnt(10)
    v_mfma_f32_16x16x32_bf16 v[32:35], v[72:75], v[204:207], v[32:35]
    ds_read2_b32 v[132:133], v62 offset0:16 offset1:15
    ds_read2_b32 v[134:135], v62 offset0:14 offset1:13
    v_mfma_f32_16x16x32_bf16 v[36:39], v[104:107], v[204:207], v[36:39]
    ds_read_b128 v[204:207], v2 offset:3200
    s_waitcnt lgkmcnt(6)
    v_mfma_f32_16x16x32_bf16 v[32:35], v[76:79], v[208:211], v[32:35]
    ds_read2_b32 v[144:145], v62 offset0:64 offset1:63
    ds_read2_b32 v[146:147], v62 offset0:62 offset1:61
    v_mfma_f32_16x16x32_bf16 v[36:39], v[108:111], v[208:211], v[36:39]
    ds_read_b128 v[208:211], v2 offset:3264
    ds_read2_b32 v[136:137], v62 offset0:32 offset1:31
    v_mfma_f32_16x16x32_bf16 v[32:35], v[80:83], v[212:215], v[32:35]
    ds_read2_b32 v[138:139], v62 offset0:30 offset1:29
    ds_read2_b32 v[148:149], v62 offset0:80 offset1:79
    v_mfma_f32_16x16x32_bf16 v[36:39], v[112:115], v[212:215], v[36:39]
    ds_read_b128 v[212:215], v2 offset:3328
    ds_read2_b32 v[150:151], v62 offset0:78 offset1:77
    v_mfma_f32_16x16x32_bf16 v[32:35], v[84:87], v[216:219], v[32:35]
    ds_read2_b32 v[140:141], v62 offset0:48 offset1:47
    ds_read2_b32 v[142:143], v62 offset0:46 offset1:45
    v_mfma_f32_16x16x32_bf16 v[36:39], v[116:119], v[216:219], v[36:39]
    s_mov_b64 exec, s[70:71]
    global_load_dword v10, v246, s[38:39]
    s_mov_b64 exec, -1
    v_mfma_f32_16x16x32_bf16 v[32:35], v[88:91], v[220:223], v[32:35]
    ds_read_b128 v[216:219], v2 offset:3392
    ds_read2_b32 v[152:153], v62 offset0:96 offset1:95
    v_mfma_f32_16x16x32_bf16 v[36:39], v[120:123], v[220:223], v[36:39]
    ds_read_b128 v[220:223], v2 offset:3456
    ds_read2_b32 v[154:155], v62 offset0:94 offset1:93
    v_mfma_f32_16x16x32_bf16 v[32:35], v[92:95], v[224:227], v[32:35]
    ds_read2_b32 v[156:157], v62 offset0:112 offset1:111
    ds_read2_b32 v[158:159], v62 offset0:110 offset1:109
    v_mfma_f32_16x16x32_bf16 v[36:39], v[124:127], v[224:227], v[36:39]
    ds_read_b128 v[224:227], v2 offset:3520
    ds_read2_b32 v[160:161], v62 offset0:128 offset1:127
    v_mfma_f32_16x16x32_bf16 v[32:35], v[64:67], v[196:199], v[32:35]
    ds_read2_b32 v[162:163], v62 offset0:126 offset1:125
    ds_read2_b32 v[164:165], v62 offset0:144 offset1:143
    v_mfma_f32_16x16x32_bf16 v[36:39], v[96:99], v[196:199], v[36:39]
    ds_read2_b32 v[166:167], v62 offset0:142 offset1:141
    ds_read2_b32 v[168:169], v62 offset0:160 offset1:159
    v_mfma_f32_16x16x32_bf16 v[40:43], v[128:131], v[196:199], 0
    ds_read2_b32 v[170:171], v62 offset0:158 offset1:157
    s_mov_b32 m0, s68
    v_mfma_f32_16x16x32_bf16 v[48:51], v[28:31], v[196:199], 0
    s_waitcnt lgkmcnt(5)
    v_and_b32 v240, 0xffff0000, v233
    v_mfma_f32_16x16x32_bf16 v[172:175], v[196:199], v[12:15], 0
    v_lshlrev_b32_e64 v241, 16, v233
    v_and_b32 v242, 0xffff0000, v232
    v_mfma_f32_16x16x32_bf16 v[176:179], v[196:199], v[16:19], 0
    v_lshlrev_b32_e64 v243, 16, v232
    v_sub_f32_e64 v32, v32, v240
    v_mfma_f32_16x16x32_bf16 v[188:191], v[196:199], v[20:23], 0
    ds_read_b128 v[196:199], v2 offset:3072
    v_sub_f32_e64 v33, v33, v241
    v_mfma_f32_16x16x32_bf16 v[180:183], v[228:231], v[12:15], 0
    v_sub_f32_e64 v34, v34, v242
    v_sub_f32_e64 v35, v35, v243
    v_mfma_f32_16x16x32_bf16 v[184:187], v[228:231], v[16:19], 0
    v_cvt_pk_bf16_f32 v172, v172, v176
    v_cvt_pk_bf16_f32 v173, v173, v177
    v_mfma_f32_16x16x32_bf16 v[192:195], v[228:231], v[24:27], 0
    ds_read_b128 v[228:231], v2 offset:3088
    v_cvt_pk_bf16_f32 v174, v174, v178
    v_mfma_f32_16x16x32_bf16 v[36:39], v[68:71], v[200:203], v[36:39]
    v_cvt_pk_bf16_f32 v175, v175, v179
    v_fma_f32 v32, v236, v32, v240
    v_mfma_f32_16x16x32_bf16 v[40:43], v[100:103], v[200:203], v[40:43]
    ds_read_b128 v[200:203], v2 offset:2624
    v_fma_f32 v33, v237, v33, v241
    v_mfma_f32_16x16x32_bf16 v[36:39], v[72:75], v[204:207], v[36:39]
    v_cvt_pk_bf16_f32 v180, v180, v184
    v_cvt_pk_bf16_f32 v181, v181, v185
    v_mfma_f32_16x16x32_bf16 v[40:43], v[104:107], v[204:207], v[40:43]
    v_cvt_pk_bf16_f32 v182, v182, v186
    v_cvt_pk_bf16_f32 v183, v183, v187
    v_mfma_f32_16x16x32_bf16 v[36:39], v[76:79], v[208:211], v[36:39]
    v_fma_f32 v34, v238, v34, v242
    v_fma_f32 v35, v239, v35, v243
    v_mfma_f32_16x16x32_bf16 v[40:43], v[108:111], v[208:211], v[40:43]
    ds_read_b64 v[232:233], v3 offset:3096
    v_cvt_pk_bf16_f32 v188, v188, v192
    v_mfma_f32_16x16x32_bf16 v[36:39], v[80:83], v[212:215], v[36:39]
    ds_read_b128 v[236:239], v4 offset:1024
    v_cvt_pk_bf16_f32 v189, v189, v193
    v_mfma_f32_16x16x32_bf16 v[40:43], v[112:115], v[212:215], v[40:43]
    ds_read_b128 v[204:207], v2 offset:2688
    v_cvt_pk_bf16_f32 v190, v190, v194
    v_mfma_f32_16x16x32_bf16 v[36:39], v[84:87], v[216:219], v[36:39]
    ds_read_b128 v[208:211], v2 offset:2752
    v_cvt_pk_bf16_f32 v191, v191, v195
    v_mfma_f32_16x16x32_bf16 v[40:43], v[116:119], v[216:219], v[40:43]
    ds_read_b128 v[212:215], v2 offset:2816
    v_cvt_pk_bf16_f32 v234, v32, v33
    v_mfma_f32_16x16x32_bf16 v[36:39], v[88:91], v[220:223], v[36:39]
    s_waitcnt lgkmcnt(3)
    v_and_b32 v240, 0xffff0000, v233
    v_mfma_f32_16x16x32_bf16 v[40:43], v[120:123], v[220:223], v[40:43]
    v_lshlrev_b32_e64 v241, 16, v233
    v_and_b32 v242, 0xffff0000, v232
    v_mfma_f32_16x16x32_bf16 v[36:39], v[92:95], v[224:227], v[36:39]
    ds_read_b128 v[216:219], v2 offset:2880
    v_lshlrev_b32_e64 v243, 16, v232
    v_mfma_f32_16x16x32_bf16 v[40:43], v[124:127], v[224:227], v[40:43]
    ds_read_b128 v[220:223], v2 offset:2944
    v_cvt_pk_bf16_f32 v235, v34, v35
    v_mfma_f32_16x16x32_bf16 v[36:39], v[64:67], v[196:199], v[36:39]
    ds_write_b64 v5, v[234:235] offset:0
    v_mfma_f32_16x16x32_bf16 v[40:43], v[96:99], v[196:199], v[40:43]
    ds_read_b128 v[224:227], v2 offset:3008
    v_mfma_f32_16x16x32_bf16 v[44:47], v[128:131], v[196:199], 0
    v_mfma_f32_16x16x32_bf16 v[52:55], v[28:31], v[196:199], 0
    v_mfma_f32_16x16x32_bf16 v[40:43], v[172:175], v[132:135], v[40:43]
    v_mfma_f32_16x16x32_bf16 v[40:43], v[180:183], v[144:147], v[40:43]
    v_mfma_f32_16x16x32_bf16 v[44:47], v[172:175], v[136:139], v[44:47]
    v_sub_f32_e64 v36, v36, v240
    v_sub_f32_e64 v37, v37, v241
    v_mfma_f32_16x16x32_bf16 v[44:47], v[180:183], v[148:151], v[44:47]
    v_sub_f32_e64 v38, v38, v242
    v_sub_f32_e64 v39, v39, v243
    v_mfma_f32_16x16x32_bf16 v[48:51], v[172:175], v[140:143], v[48:51]
    v_fma_f32 v36, v236, v36, v240
    v_fma_f32 v37, v237, v37, v241
    v_mfma_f32_16x16x32_bf16 v[48:51], v[180:183], v[152:155], v[48:51]
    v_fma_f32 v38, v238, v38, v242
    v_fma_f32 v39, v239, v39, v243
    v_mfma_f32_16x16x32_bf16 v[48:51], v[188:191], v[156:159], v[48:51]
    v_cvt_pk_bf16_f32 v234, v36, v37
    v_cvt_pk_bf16_f32 v235, v38, v39
    v_mfma_f32_16x16x32_bf16 v[52:55], v[188:191], v[160:163], v[52:55]
    ds_write_b64 v5, v[234:235] offset:576
    v_mfma_f32_16x16x32_bf16 v[56:59], v[188:191], v[164:167], 0
    ds_read_b64 v[232:233], v3 offset:2584
    ds_read_b128 v[236:239], v4 offset:2048
    v_mfma_f32_16x16x32_bf16 v[60:63], v[188:191], v[168:171], 0
    v_mfma_f32_16x16x32_bf16 v[172:175], v[196:199], v[12:15], 0
    v_mfma_f32_16x16x32_bf16 v[176:179], v[196:199], v[16:19], 0
    s_waitcnt lgkmcnt(2)
    s_barrier
    v_mfma_f32_16x16x32_bf16 v[188:191], v[196:199], v[20:23], 0
    ds_read_b64_tr_b16 v[244:245], v8 offset:0
    ds_read_b64_tr_b16 v[246:247], v9 offset:0
    v_mfma_f32_16x16x32_bf16 v[180:183], v[228:231], v[12:15], 0
    s_waitcnt vmcnt(1)
    ds_read_b128 v[196:199], v2 offset:2560
    v_mfma_f32_16x16x32_bf16 v[184:187], v[228:231], v[16:19], 0
    v_cvt_pk_bf16_f32 v172, v172, v176
    v_cvt_pk_bf16_f32 v173, v173, v177
    v_mfma_f32_16x16x32_bf16 v[192:195], v[228:231], v[24:27], 0
    ds_read_b128 v[228:231], v2 offset:2576
    v_cvt_pk_bf16_f32 v174, v174, v178
    v_mfma_f32_16x16x32_bf16 v[40:43], v[68:71], v[200:203], v[40:43]
    s_waitcnt lgkmcnt(2)
    buffer_store_dwordx4 v[244:247], v11, s[52:55], s60 offen
    v_mfma_f32_16x16x32_bf16 v[44:47], v[100:103], v[200:203], v[44:47]
    ds_read_b128 v[200:203], v2 offset:2112
    v_cvt_pk_bf16_f32 v175, v175, v179
    v_mfma_f32_16x16x32_bf16 v[40:43], v[72:75], v[204:207], v[40:43]
    v_cvt_pk_bf16_f32 v180, v180, v184
    v_cvt_pk_bf16_f32 v181, v181, v185
    v_mfma_f32_16x16x32_bf16 v[44:47], v[104:107], v[204:207], v[44:47]
    v_cvt_pk_bf16_f32 v182, v182, v186
    v_cvt_pk_bf16_f32 v183, v183, v187
    v_mfma_f32_16x16x32_bf16 v[40:43], v[76:79], v[208:211], v[40:43]
    ds_read_b128 v[204:207], v2 offset:2176
    v_cvt_pk_bf16_f32 v188, v188, v192
    v_mfma_f32_16x16x32_bf16 v[44:47], v[108:111], v[208:211], v[44:47]
    ds_read_b128 v[208:211], v2 offset:2240
    v_cvt_pk_bf16_f32 v189, v189, v193
    v_mfma_f32_16x16x32_bf16 v[40:43], v[80:83], v[212:215], v[40:43]
    v_cvt_pk_bf16_f32 v190, v190, v194
    v_cvt_pk_bf16_f32 v191, v191, v195
    v_mfma_f32_16x16x32_bf16 v[44:47], v[112:115], v[212:215], v[44:47]
    ds_read_b128 v[212:215], v2 offset:2304
    v_and_b32 v240, 0xffff0000, v233
    v_mfma_f32_16x16x32_bf16 v[40:43], v[84:87], v[216:219], v[40:43]
    v_lshlrev_b32_e64 v241, 16, v233
    v_and_b32 v242, 0xffff0000, v232
    v_mfma_f32_16x16x32_bf16 v[44:47], v[116:119], v[216:219], v[44:47]
    ds_read_b128 v[216:219], v2 offset:2368
    v_lshlrev_b32_e64 v243, 16, v232
    v_mfma_f32_16x16x32_bf16 v[40:43], v[88:91], v[220:223], v[40:43]
    v_perm_b32 v244, v248, v252, s64
    v_perm_b32 v245, v248, v252, s65
    v_mfma_f32_16x16x32_bf16 v[44:47], v[120:123], v[220:223], v[44:47]
    ds_read_b128 v[220:223], v2 offset:2432
    v_perm_b32 v246, v249, v253, s64
    v_mfma_f32_16x16x32_bf16 v[40:43], v[92:95], v[224:227], v[40:43]
    ds_write_addtid_b32 v244 offset:0
    v_perm_b32 v247, v249, v253, s65
    v_mfma_f32_16x16x32_bf16 v[44:47], v[124:127], v[224:227], v[44:47]
    ds_read_b128 v[224:227], v2 offset:2496
    s_waitcnt lgkmcnt(3)
    v_mfma_f32_16x16x32_bf16 v[40:43], v[64:67], v[196:199], v[40:43]
    ds_write_addtid_b32 v245 offset:19008
    v_perm_b32 v244, v250, v254, s64
    v_mfma_f32_16x16x32_bf16 v[44:47], v[96:99], v[196:199], v[44:47]
    ds_write_addtid_b32 v246 offset:38016
    v_perm_b32 v245, v250, v254, s65
    v_mfma_f32_16x16x32_bf16 v[48:51], v[128:131], v[196:199], v[48:51]
    ds_write_addtid_b32 v247 offset:57024
    v_perm_b32 v246, v251, v255, s64
    v_mfma_f32_16x16x32_bf16 v[56:59], v[28:31], v[196:199], v[56:59]
    v_sub_f32_e64 v40, v40, v240
    v_sub_f32_e64 v41, v41, v241
    v_mfma_f32_16x16x32_bf16 v[44:47], v[172:175], v[132:135], v[44:47]
    v_sub_f32_e64 v42, v42, v242
    v_sub_f32_e64 v43, v43, v243
    v_mfma_f32_16x16x32_bf16 v[44:47], v[180:183], v[144:147], v[44:47]
    v_fma_f32 v40, v236, v40, v240
    v_fma_f32 v41, v237, v41, v241
    v_mfma_f32_16x16x32_bf16 v[48:51], v[172:175], v[136:139], v[48:51]
    v_fma_f32 v42, v238, v42, v242
    v_fma_f32 v43, v239, v43, v243
    v_mfma_f32_16x16x32_bf16 v[48:51], v[180:183], v[148:151], v[48:51]
    v_cvt_pk_bf16_f32 v234, v40, v41
    v_cvt_pk_bf16_f32 v235, v42, v43
    v_mfma_f32_16x16x32_bf16 v[52:55], v[172:175], v[140:143], v[52:55]
    ds_write_b64 v5, v[234:235] offset:1152
    v_mfma_f32_16x16x32_bf16 v[52:55], v[180:183], v[152:155], v[52:55]
    v_perm_b32 v247, v251, v255, s65
    v_mfma_f32_16x16x32_bf16 v[52:55], v[188:191], v[156:159], v[52:55]
    ds_read_b64 v[248:249], v3 offset:2072
    ds_read_b128 v[252:255], v4 offset:3072
    v_mfma_f32_16x16x32_bf16 v[56:59], v[188:191], v[160:163], v[56:59]
    s_mov_b32 m0, s69
    v_mfma_f32_16x16x32_bf16 v[60:63], v[188:191], v[164:167], v[60:63]
    ds_write_addtid_b32 v244 offset:0
    ds_write_addtid_b32 v245 offset:19008
    v_mfma_f32_16x16x32_bf16 v[172:175], v[196:199], v[12:15], 0
    ds_write_addtid_b32 v246 offset:38016
    ds_write_addtid_b32 v247 offset:57024
    v_mfma_f32_16x16x32_bf16 v[176:179], v[196:199], v[16:19], 0
    s_waitcnt lgkmcnt(4)
    v_and_b32 v240, 0xffff0000, v249
    v_mfma_f32_16x16x32_bf16 v[188:191], v[196:199], v[20:23], 0
    ds_read_b128 v[196:199], v2 offset:2048
    v_lshlrev_b32_e64 v241, 16, v249
    v_mfma_f32_16x16x32_bf16 v[180:183], v[228:231], v[12:15], 0
    v_and_b32 v242, 0xffff0000, v248
    v_lshlrev_b32_e64 v243, 16, v248
    v_mfma_f32_16x16x32_bf16 v[184:187], v[228:231], v[16:19], 0
    v_cvt_pk_bf16_f32 v172, v172, v176
    v_cvt_pk_bf16_f32 v173, v173, v177
    v_mfma_f32_16x16x32_bf16 v[192:195], v[228:231], v[24:27], 0
    ds_read_b128 v[228:231], v2 offset:2064
    v_cvt_pk_bf16_f32 v174, v174, v178
    v_mfma_f32_16x16x32_bf16 v[44:47], v[68:71], v[200:203], v[44:47]
    v_cvt_pk_bf16_f32 v175, v175, v179
    v_mfma_f32_16x16x32_bf16 v[48:51], v[100:103], v[200:203], v[48:51]
    v_cvt_pk_bf16_f32 v180, v180, v184
    v_cvt_pk_bf16_f32 v181, v181, v185
    v_mfma_f32_16x16x32_bf16 v[44:47], v[72:75], v[204:207], v[44:47]
    v_cvt_pk_bf16_f32 v182, v182, v186
    v_cvt_pk_bf16_f32 v183, v183, v187
    v_mfma_f32_16x16x32_bf16 v[48:51], v[104:107], v[204:207], v[48:51]
    v_cvt_pk_bf16_f32 v188, v188, v192
    v_cvt_pk_bf16_f32 v189, v189, v193
    v_mfma_f32_16x16x32_bf16 v[44:47], v[76:79], v[208:211], v[44:47]
    v_cvt_pk_bf16_f32 v190, v190, v194
    v_cvt_pk_bf16_f32 v191, v191, v195
    v_mfma_f32_16x16x32_bf16 v[48:51], v[108:111], v[208:211], v[48:51]
    s_waitcnt lgkmcnt(0)
    s_barrier
    v_mfma_f32_16x16x32_bf16 v[44:47], v[80:83], v[212:215], v[44:47]
    ds_read_b128 v[200:203], v2 offset:1600
    ds_read_b128 v[204:207], v2 offset:1664
    v_mfma_f32_16x16x32_bf16 v[48:51], v[112:115], v[212:215], v[48:51]
    ds_read_b128 v[208:211], v2 offset:1728
    ds_read_b128 v[212:215], v2 offset:1792
    v_mfma_f32_16x16x32_bf16 v[44:47], v[84:87], v[216:219], v[44:47]
    ds_read_b64 v[232:233], v3 offset:1560
    v_and_b32_e64 v6, 7, v1
    v_mfma_f32_16x16x32_bf16 v[48:51], v[116:119], v[216:219], v[48:51]
    ds_read_b128 v[216:219], v2 offset:1856
    ds_read_b128 v[236:239], v4 offset:4096
    v_mfma_f32_16x16x32_bf16 v[44:47], v[88:91], v[220:223], v[44:47]
    v_lshl_add_u32 v6, v6, 7, s29
    v_mfma_f32_16x16x32_bf16 v[48:51], v[120:123], v[220:223], v[48:51]
    ds_read_b128 v[220:223], v2 offset:1920
    v_mfma_f32_16x16x32_bf16 v[44:47], v[92:95], v[224:227], v[44:47]
    v_mfma_f32_16x16x32_bf16 v[48:51], v[124:127], v[224:227], v[48:51]
    ds_read_b128 v[224:227], v2 offset:1984
    v_mfma_f32_16x16x32_bf16 v[44:47], v[64:67], v[196:199], v[44:47]
    v_mfma_f32_16x16x32_bf16 v[48:51], v[96:99], v[196:199], v[48:51]
    v_mfma_f32_16x16x32_bf16 v[52:55], v[128:131], v[196:199], v[52:55]
    v_mfma_f32_16x16x32_bf16 v[60:63], v[28:31], v[196:199], v[60:63]
    v_mfma_f32_16x16x32_bf16 v[48:51], v[172:175], v[132:135], v[48:51]
    v_mfma_f32_16x16x32_bf16 v[48:51], v[180:183], v[144:147], v[48:51]
    v_mfma_f32_16x16x32_bf16 v[52:55], v[172:175], v[136:139], v[52:55]
    v_mfma_f32_16x16x32_bf16 v[52:55], v[180:183], v[148:151], v[52:55]
    v_mfma_f32_16x16x32_bf16 v[56:59], v[172:175], v[140:143], v[56:59]
    v_sub_f32_e64 v44, v44, v240
    v_sub_f32_e64 v45, v45, v241
    v_mfma_f32_16x16x32_bf16 v[56:59], v[180:183], v[152:155], v[56:59]
    v_sub_f32_e64 v46, v46, v242
    v_sub_f32_e64 v47, v47, v243
    v_mfma_f32_16x16x32_bf16 v[56:59], v[188:191], v[156:159], v[56:59]
    v_fma_f32 v44, v252, v44, v240
    v_fma_f32 v45, v253, v45, v241
    v_mfma_f32_16x16x32_bf16 v[60:63], v[188:191], v[160:163], v[60:63]
    v_fma_f32 v46, v254, v46, v242
    v_fma_f32 v47, v255, v47, v243
    v_mfma_f32_16x16x32_bf16 v[172:175], v[196:199], v[12:15], 0
    v_cvt_pk_bf16_f32 v250, v44, v45
    v_cvt_pk_bf16_f32 v251, v46, v47
    v_mfma_f32_16x16x32_bf16 v[176:179], v[196:199], v[16:19], 0
    ds_write_b64 v5, v[250:251] offset:1728
    v_mfma_f32_16x16x32_bf16 v[188:191], v[196:199], v[20:23], 0
    ds_read_b128 v[196:199], v2 offset:1536
    ds_read_b64 v[248:249], v3 offset:1048
    v_mfma_f32_16x16x32_bf16 v[180:183], v[228:231], v[12:15], 0
    s_waitcnt lgkmcnt(3)
    v_and_b32 v240, 0xffff0000, v233
    v_mfma_f32_16x16x32_bf16 v[184:187], v[228:231], v[16:19], 0
    v_cvt_pk_bf16_f32 v172, v172, v176
    v_cvt_pk_bf16_f32 v173, v173, v177
    v_mfma_f32_16x16x32_bf16 v[192:195], v[228:231], v[24:27], 0
    s_waitcnt lgkmcnt(2)
    s_barrier
    v_mfma_f32_16x16x32_bf16 v[48:51], v[68:71], v[200:203], v[48:51]
    ds_read_b64_tr_b16 v[244:245], v8 offset:1152
    v_cvt_pk_bf16_f32 v174, v174, v178
    v_mfma_f32_16x16x32_bf16 v[52:55], v[100:103], v[200:203], v[52:55]
    ds_read_b64_tr_b16 v[246:247], v9 offset:1152
    v_cvt_pk_bf16_f32 v175, v175, v179
    v_mfma_f32_16x16x32_bf16 v[48:51], v[72:75], v[204:207], v[48:51]
    ds_read_b128 v[228:231], v2 offset:1552
    v_cvt_pk_bf16_f32 v180, v180, v184
    v_mfma_f32_16x16x32_bf16 v[52:55], v[104:107], v[204:207], v[52:55]
    ds_read_b128 v[200:203], v2 offset:1088
    v_cvt_pk_bf16_f32 v181, v181, v185
    v_mfma_f32_16x16x32_bf16 v[48:51], v[76:79], v[208:211], v[48:51]
    ds_read_b128 v[204:207], v2 offset:1152
    v_cvt_pk_bf16_f32 v182, v182, v186
    v_mfma_f32_16x16x32_bf16 v[52:55], v[108:111], v[208:211], v[52:55]
    s_waitcnt lgkmcnt(3)
    buffer_store_dwordx4 v[244:247], v11, s[52:55], s9 offen
    v_mfma_f32_16x16x32_bf16 v[48:51], v[80:83], v[212:215], v[48:51]
    ds_read_b128 v[208:211], v2 offset:1216
    v_cvt_pk_bf16_f32 v183, v183, v187
    v_mfma_f32_16x16x32_bf16 v[52:55], v[112:115], v[212:215], v[52:55]
    ds_read_b128 v[212:215], v2 offset:1280
    v_cvt_pk_bf16_f32 v188, v188, v192
    v_mfma_f32_16x16x32_bf16 v[48:51], v[84:87], v[216:219], v[48:51]
    v_cvt_pk_bf16_f32 v189, v189, v193
    v_cvt_pk_bf16_f32 v190, v190, v194
    v_mfma_f32_16x16x32_bf16 v[52:55], v[116:119], v[216:219], v[52:55]
    ds_read_b128 v[216:219], v2 offset:1344
    v_cvt_pk_bf16_f32 v191, v191, v195
    v_mfma_f32_16x16x32_bf16 v[48:51], v[88:91], v[220:223], v[48:51]
    v_lshlrev_b32_e64 v241, 16, v233
    v_and_b32 v242, 0xffff0000, v232
    v_mfma_f32_16x16x32_bf16 v[52:55], v[120:123], v[220:223], v[52:55]
    ds_read_b128 v[220:223], v2 offset:1408
    v_lshlrev_b32_e64 v243, 16, v232
    v_mfma_f32_16x16x32_bf16 v[48:51], v[92:95], v[224:227], v[48:51]
    ds_read_b128 v[252:255], v4 offset:5120
    v_mfma_f32_16x16x32_bf16 v[52:55], v[124:127], v[224:227], v[52:55]
    ds_read_b128 v[224:227], v2 offset:1472
    v_mfma_f32_16x16x32_bf16 v[48:51], v[64:67], v[196:199], v[48:51]
    v_mfma_f32_16x16x32_bf16 v[52:55], v[96:99], v[196:199], v[52:55]
    v_mfma_f32_16x16x32_bf16 v[56:59], v[128:131], v[196:199], v[56:59]
    s_waitcnt lgkmcnt(1)
    v_and_b32 v20, 0xffff0000, v249
    v_mfma_f32_16x16x32_bf16 v[52:55], v[172:175], v[132:135], v[52:55]
    v_lshlrev_b32_e64 v21, 16, v249
    v_and_b32 v22, 0xffff0000, v248
    v_mfma_f32_16x16x32_bf16 v[52:55], v[180:183], v[144:147], v[52:55]
    v_sub_f32_e64 v48, v48, v240
    v_sub_f32_e64 v49, v49, v241
    v_mfma_f32_16x16x32_bf16 v[56:59], v[172:175], v[136:139], v[56:59]
    v_sub_f32_e64 v50, v50, v242
    v_sub_f32_e64 v51, v51, v243
    v_mfma_f32_16x16x32_bf16 v[56:59], v[180:183], v[148:151], v[56:59]
    v_fma_f32 v48, v236, v48, v240
    v_fma_f32 v49, v237, v49, v241
    v_mfma_f32_16x16x32_bf16 v[60:63], v[172:175], v[140:143], v[60:63]
    v_fma_f32 v50, v238, v50, v242
    v_fma_f32 v51, v239, v51, v243
    v_mfma_f32_16x16x32_bf16 v[60:63], v[180:183], v[152:155], v[60:63]
    v_cvt_pk_bf16_f32 v234, v48, v49
    v_cvt_pk_bf16_f32 v235, v50, v51
    v_mfma_f32_16x16x32_bf16 v[60:63], v[188:191], v[156:159], v[60:63]
    ds_write_b64 v5, v[234:235] offset:2304
    v_mfma_f32_16x16x32_bf16 v[172:175], v[196:199], v[12:15], 0
    ds_read_b64 v[232:233], v3 offset:536
    v_lshlrev_b32_e64 v23, 16, v248
    v_mfma_f32_16x16x32_bf16 v[176:179], v[196:199], v[16:19], 0
    ds_read_b128 v[196:199], v2 offset:1024
    ds_read_b128 v[236:239], v4 offset:6144
    v_mfma_f32_16x16x32_bf16 v[180:183], v[228:231], v[12:15], 0
    v_mfma_f32_16x16x32_bf16 v[184:187], v[228:231], v[16:19], 0
    s_waitcnt lgkmcnt(3)
    s_barrier
    v_mfma_f32_16x16x32_bf16 v[52:55], v[68:71], v[200:203], v[52:55]
    ds_read_b128 v[228:231], v2 offset:1040
    v_cvt_pk_bf16_f32 v172, v172, v176
    v_mfma_f32_16x16x32_bf16 v[52:55], v[72:75], v[204:207], v[52:55]
    v_cvt_pk_bf16_f32 v173, v173, v177
    v_cvt_pk_bf16_f32 v174, v174, v178
    v_mfma_f32_16x16x32_bf16 v[52:55], v[76:79], v[208:211], v[52:55]
    v_cvt_pk_bf16_f32 v175, v175, v179
    v_cvt_pk_bf16_f32 v180, v180, v184
    v_mfma_f32_16x16x32_bf16 v[52:55], v[80:83], v[212:215], v[52:55]
    v_cvt_pk_bf16_f32 v181, v181, v185
    v_cvt_pk_bf16_f32 v182, v182, v186
    v_mfma_f32_16x16x32_bf16 v[52:55], v[84:87], v[216:219], v[52:55]
    v_cvt_pk_bf16_f32 v183, v183, v187
    v_mfma_f32_16x16x32_bf16 v[52:55], v[88:91], v[220:223], v[52:55]
    s_waitcnt lgkmcnt(0)
    v_and_b32 v240, 0xffff0000, v233
    v_mfma_f32_16x16x32_bf16 v[52:55], v[92:95], v[224:227], v[52:55]
    v_lshlrev_b32_e64 v241, 16, v233
    v_and_b32 v242, 0xffff0000, v232
    v_mfma_f32_16x16x32_bf16 v[52:55], v[64:67], v[196:199], v[52:55]
    v_lshlrev_b32_e64 v243, 16, v232
    v_mfma_f32_16x16x32_bf16 v[56:59], v[100:103], v[200:203], v[56:59]
    ds_read_b128 v[200:203], v2 offset:576
    v_mfma_f32_16x16x32_bf16 v[56:59], v[104:107], v[204:207], v[56:59]
    ds_read_b128 v[204:207], v2 offset:640
    v_mfma_f32_16x16x32_bf16 v[56:59], v[108:111], v[208:211], v[56:59]
    ds_read_b128 v[208:211], v2 offset:704
    v_mfma_f32_16x16x32_bf16 v[56:59], v[112:115], v[212:215], v[56:59]
    ds_read_b128 v[212:215], v2 offset:768
    v_sub_f32_e64 v52, v52, v20
    v_mfma_f32_16x16x32_bf16 v[56:59], v[116:119], v[216:219], v[56:59]
    ds_read_b128 v[216:219], v2 offset:832
    v_sub_f32_e64 v53, v53, v21
    v_mfma_f32_16x16x32_bf16 v[56:59], v[120:123], v[220:223], v[56:59]
    ds_read_b128 v[220:223], v2 offset:896
    v_sub_f32_e64 v54, v54, v22
    v_mfma_f32_16x16x32_bf16 v[56:59], v[124:127], v[224:227], v[56:59]
    ds_read_b128 v[224:227], v2 offset:960
    v_sub_f32_e64 v55, v55, v23
    v_mfma_f32_16x16x32_bf16 v[56:59], v[96:99], v[196:199], v[56:59]
    v_fma_f32 v52, v252, v52, v20
    v_fma_f32 v53, v253, v53, v21
    v_mfma_f32_16x16x32_bf16 v[60:63], v[128:131], v[196:199], v[60:63]
    v_fma_f32 v54, v254, v54, v22
    v_fma_f32 v55, v255, v55, v23
    v_mfma_f32_16x16x32_bf16 v[56:59], v[172:175], v[132:135], v[56:59]
    v_cvt_pk_bf16_f32 v250, v52, v53
    v_cvt_pk_bf16_f32 v251, v54, v55
    v_mfma_f32_16x16x32_bf16 v[56:59], v[180:183], v[144:147], v[56:59]
    ds_write_b64 v5, v[250:251] offset:2880
    v_mfma_f32_16x16x32_bf16 v[60:63], v[172:175], v[136:139], v[60:63]
    ds_read_b64 v[248:249], v3 offset:24
    ds_read_b128 v[252:255], v4 offset:7168
    v_mfma_f32_16x16x32_bf16 v[60:63], v[180:183], v[148:151], v[60:63]
    v_mfma_f32_16x16x32_bf16 v[172:175], v[196:199], v[12:15], 0
    v_mfma_f32_16x16x32_bf16 v[176:179], v[196:199], v[16:19], 0
    ds_read_b128 v[196:199], v2 offset:512
    v_mfma_f32_16x16x32_bf16 v[180:183], v[228:231], v[12:15], 0
    s_waitcnt lgkmcnt(1)
    s_barrier
    v_mfma_f32_16x16x32_bf16 v[184:187], v[228:231], v[16:19], 0
    s_setprio 1
    ds_read_b64_tr_b16 v[244:245], v8 offset:2304
    v_mfma_f32_16x16x32_bf16 v[56:59], v[68:71], v[200:203], v[56:59]
    global_load_dword v10, v6, s[46:47] sc1
    v_mfma_f32_16x16x32_bf16 v[56:59], v[72:75], v[204:207], v[56:59]
    ds_read_b64_tr_b16 v[246:247], v9 offset:2304
    v_cvt_pk_bf16_f32 v172, v172, v176
    v_mfma_f32_16x16x32_bf16 v[56:59], v[76:79], v[208:211], v[56:59]
    v_cvt_pk_bf16_f32 v173, v173, v177
    v_cvt_pk_bf16_f32 v174, v174, v178
    v_mfma_f32_16x16x32_bf16 v[56:59], v[80:83], v[212:215], v[56:59]
    v_cvt_pk_bf16_f32 v175, v175, v179
    v_cvt_pk_bf16_f32 v180, v180, v184
    v_mfma_f32_16x16x32_bf16 v[56:59], v[84:87], v[216:219], v[56:59]
    v_cvt_pk_bf16_f32 v181, v181, v185
    v_cvt_pk_bf16_f32 v182, v182, v186
    v_mfma_f32_16x16x32_bf16 v[56:59], v[88:91], v[220:223], v[56:59]
    s_waitcnt lgkmcnt(0)
    buffer_store_dwordx4 v[244:247], v11, s[52:55], s8 offen
    v_mfma_f32_16x16x32_bf16 v[56:59], v[92:95], v[224:227], v[56:59]
    v_cvt_pk_bf16_f32 v183, v183, v187
    v_and_b32 v20, 0xffff0000, v249
    v_mfma_f32_16x16x32_bf16 v[56:59], v[64:67], v[196:199], v[56:59]
    v_lshlrev_b32_e64 v21, 16, v249
    v_and_b32 v22, 0xffff0000, v248
    v_mfma_f32_16x16x32_bf16 v[60:63], v[100:103], v[200:203], v[60:63]
    ds_read_b128 v[200:203], v2 offset:64
    v_lshlrev_b32_e64 v23, 16, v248
    v_mfma_f32_16x16x32_bf16 v[60:63], v[104:107], v[204:207], v[60:63]
    ds_read_b128 v[204:207], v2 offset:128
    v_mfma_f32_16x16x32_bf16 v[60:63], v[108:111], v[208:211], v[60:63]
    v_sub_f32_e64 v56, v56, v240
    v_sub_f32_e64 v57, v57, v241
    v_sub_f32_e64 v58, v58, v242
    v_sub_f32_e64 v59, v59, v243
    v_fma_f32 v56, v236, v56, v240
    v_fma_f32 v57, v237, v57, v241
    v_fma_f32 v58, v238, v58, v242
    v_fma_f32 v59, v239, v59, v243
    v_cvt_pk_bf16_f32 v234, v56, v57
    v_cvt_pk_bf16_f32 v235, v58, v59
    v_mfma_f32_16x16x32_bf16 v[60:63], v[112:115], v[212:215], v[60:63]
    ds_read_b128 v[208:211], v2 offset:192
    ds_read_b128 v[212:215], v2 offset:256
    v_mfma_f32_16x16x32_bf16 v[60:63], v[116:119], v[216:219], v[60:63]
    ds_write_b64 v5, v[234:235] offset:3456
    v_mfma_f32_16x16x32_bf16 v[60:63], v[120:123], v[220:223], v[60:63]
    s_setprio 0
    ds_read_b128 v[216:219], v2 offset:320
    ds_read_b128 v[220:223], v2 offset:384
    v_mfma_f32_16x16x32_bf16 v[60:63], v[124:127], v[224:227], v[60:63]
    ds_read_b128 v[224:227], v2 offset:448
    v_mfma_f32_16x16x32_bf16 v[60:63], v[96:99], v[196:199], v[60:63]
    ds_read_b128 v[196:199], v2 offset:0
    v_mfma_f32_16x16x32_bf16 v[60:63], v[172:175], v[132:135], v[60:63]
    s_waitcnt vmcnt(1)
    v_cmp_ne_u32 vcc, s66, v10
    s_cbranch_vccnz LC_nogaty
    global_load_dwordx4 v[156:159], v7, s[46:47] offset:0 sc1
    global_load_dwordx4 v[160:163], v7, s[46:47] offset:1024 sc1
LC_gat1y:
    v_mfma_f32_16x16x32_bf16 v[60:63], v[180:183], v[144:147], v[60:63]
    s_waitcnt lgkmcnt(2)
    s_barrier
    v_mfma_f32_16x16x32_bf16 v[60:63], v[68:71], v[200:203], v[60:63]
    v_mfma_f32_16x16x32_bf16 v[60:63], v[72:75], v[204:207], v[60:63]
    v_mfma_f32_16x16x32_bf16 v[60:63], v[76:79], v[208:211], v[60:63]
    v_mfma_f32_16x16x32_bf16 v[60:63], v[80:83], v[212:215], v[60:63]
    v_mfma_f32_16x16x32_bf16 v[60:63], v[84:87], v[216:219], v[60:63]
    v_mfma_f32_16x16x32_bf16 v[60:63], v[88:91], v[220:223], v[60:63]
    s_waitcnt lgkmcnt(0)
    v_mfma_f32_16x16x32_bf16 v[60:63], v[92:95], v[224:227], v[60:63]
    v_mfma_f32_16x16x32_bf16 v[60:63], v[64:67], v[196:199], v[60:63]
    s_nop 7
    v_sub_f32_e64 v60, v60, v20
    v_sub_f32_e64 v61, v61, v21
    v_sub_f32_e64 v62, v62, v22
    v_sub_f32_e64 v63, v63, v23
    v_fma_f32 v60, v252, v60, v20
    v_fma_f32 v61, v253, v61, v21
    v_fma_f32 v62, v254, v62, v22
    v_fma_f32 v63, v255, v63, v23
    v_cvt_pk_bf16_f32 v250, v60, v61
    v_cvt_pk_bf16_f32 v251, v62, v63
    ds_write_b64 v5, v[250:251] offset:4032
    s_cbranch_vccnz LC_chk2y
LC_gat2y:
    s_waitcnt lgkmcnt(0)
    s_barrier
    ds_read_b64_tr_b16 v[244:245], v8 offset:3456
    ds_read_b64_tr_b16 v[246:247], v9 offset:3456
    s_waitcnt lgkmcnt(0)
    buffer_store_dwordx4 v[244:247], v11, s[52:55], s62 offen
    s_cbranch_vccnz LC_late
    s_cmp_eq_u32 s28, 1
    s_cbranch_scc1 LC_w2y
    s_waitcnt vmcnt(1)
LC_final:
    s_bfe_u32 s12, s66, 0x80000
    s_bfe_u32 s13, s66, 0x80008
    s_bfe_u32 s14, s66, 0x80010
    s_bfe_u32 s15, s66, 0x80018
    s_mov_b32 s10, 0
    s_cmp_eq_u32 s3, 7
    s_cbranch_scc1 LC_poll4
LC_poll3:
    v_xor_b32 v64, s12, v156
    v_xor_b32 v65, s13, v157
    v_xor_b32 v66, s14, v158
    v_xor_b32 v67, s15, v159
    v_xor_b32 v68, s12, v160
    v_xor_b32 v69, s13, v161
    v_xor_b32 v70, s14, v162
    v_xor_b32 v71, s15, v163
    v_or3_b32 v3, v64, v65, v66
    v_or3_b32 v4, v67, v68, v69
    v_or3_b32 v3, v70, v71, v3
    v_or_b32 v3, v3, v4
    v_and_b32 v3, 0xff, v3
    v_cmp_ne_u32 vcc, 0, v3
    s_cbranch_vccnz LC_poll3_retry
LC_poll3_ok:
    v_pk_add_f32 v[64:65], v[64:65], v[68:69]
    v_pk_add_f32 v[66:67], v[66:67], v[70:71]
    s_lshl_b32 s6, s3, 8
    s_add_u32 m0, s6, 160256
    v_permlane32_swap_b32 v64, v66
    v_permlane32_swap_b32 v65, v67
    v_pk_add_f32 v[64:65], v[64:65], v[66:67]
    s_nop 1
    v_permlane16_swap_b32 v64, v65
    v_add_f32 v64, v64, v65
    ds_write_addtid_b32 v64
    s_waitcnt lgkmcnt(0)
    s_barrier
    s_endpgm
LC_poll4:
    v_cmp_ne_u32 vcc, s66, v157
    v_and_b32 v3, 7, v1
    s_cbranch_vccnz LC_poll4_retry
LC_poll4_ok:
    v_not_b32 v64, v156
    v_and_b32 v64, 2047, v64
    v_mul_u32_u24 v4, 19008, v3
    v_lshrrev_b32 v5, 8, v64
    v_bfe_u32 v8, v64, 2, 2
    v_lshl_add_u32 v5, v5, 2, v8
    v_mul_u32_u24 v5, 144, v5
    v_bfe_u32 v8, v64, 4, 4
    v_lshl_add_u32 v4, v8, 3, v4
    v_and_b32 v8, 3, v64
    v_lshl_add_u32 v5, v8, 1, v5
    v_add_u32 v4, v4, v5
    ds_read_u16 v66, v4 offset:0
    v_lshlrev_b32 v64, 11, v64
    v_lshl_add_u32 v64, v3, 1, v64
    v_lshlrev_b32 v2, 2, v1
    v_add_u32 v2, 160256, v2
    s_waitcnt lgkmcnt(0)
    v_lshlrev_b32 v66, 16, v66
    s_barrier
    ds_read2st64_b32 v[68:69], v2 offset0:0 offset1:1
    ds_read2st64_b32 v[70:71], v2 offset0:2 offset1:3
    ds_read2st64_b32 v[72:73], v2 offset0:4 offset1:5
    ds_read_b32 v67, v2 offset:1536
    s_waitcnt lgkmcnt(2)
    v_pk_add_f32 v[68:69], v[68:69], v[70:71]
    s_waitcnt lgkmcnt(0)
    v_pk_add_f32 v[66:67], v[66:67], v[72:73]
    v_pk_add_f32 v[66:67], v[66:67], v[68:69]
    v_add_f32 v66, v66, v67
    v_cvt_pk_bf16_f32 v66, v66, v66
    buffer_store_short v66, v64, s[52:55], s60 offen
    s_endpgm
LC_poll3_retry:
    s_add_u32 s10, s10, 1
    s_cmp_ge_u32 s10, 40000
    s_cbranch_scc1 LC_poll3_ok
    s_sleep 2
    s_mov_b64 exec, vcc
    global_load_dwordx4 v[156:159], v7, s[46:47] offset:0 sc1
    global_load_dwordx4 v[160:163], v7, s[46:47] offset:1024 sc1
    s_mov_b64 exec, -1
    s_waitcnt vmcnt(0)
    s_branch LC_poll3
LC_poll4_retry:
    s_add_u32 s10, s10, 1
    s_cmp_ge_u32 s10, 40000
    s_cbranch_scc1 LC_poll4_ok
    s_sleep 2
    s_mov_b64 exec, vcc
    global_load_dwordx4 v[156:159], v7, s[46:47] offset:0 sc1
    global_load_dwordx4 v[160:163], v7, s[46:47] offset:1024 sc1
    s_mov_b64 exec, -1
    s_waitcnt vmcnt(0)
    s_branch LC_poll4
LC_nogatx:
    global_load_dword v10, v6, s[46:47] sc1
    global_load_dword v10, v6, s[46:47] sc1
    s_branch LC_gat1x
LC_chk2x:
    s_waitcnt vmcnt(1)
    v_cmp_ne_u32 vcc, s66, v10
    s_mov_b32 s28, 1
    s_cbranch_vccnz LC_gat2x
    global_load_dwordx4 v[156:159], v7, s[46:47] offset:0 sc1
    global_load_dwordx4 v[160:163], v7, s[46:47] offset:1024 sc1
    s_branch LC_gat2x
LC_w2x:
    s_waitcnt vmcnt(0)
    s_branch LC_final
LC_nogaty:
    global_load_dword v10, v6, s[46:47] sc1
    global_load_dword v10, v6, s[46:47] sc1
    s_branch LC_gat1y
LC_chk2y:
    s_waitcnt vmcnt(0)
    v_cmp_ne_u32 vcc, s66, v10
    s_mov_b32 s28, 1
    s_cbranch_vccnz LC_gat2y
    global_load_dwordx4 v[156:159], v7, s[46:47] offset:0 sc1
    global_load_dwordx4 v[160:163], v7, s[46:47] offset:1024 sc1
    s_branch LC_gat2y
LC_w2y:
    s_waitcnt vmcnt(1)
    s_branch LC_final
LC_late:
    s_mov_b32 s10, 0
LC_late1:
    global_load_dword v10, v6, s[46:47] sc1
    s_add_u32 s10, s10, 1
    s_cmp_ge_u32 s10, 40000
    s_waitcnt vmcnt(0)
    v_cmp_ne_u32 vcc, s66, v10
    s_cbranch_scc1 LC_late2
    s_cbranch_vccnz LC_late1
LC_late2:
    global_load_dwordx4 v[156:159], v7, s[46:47] offset:0 sc1
    global_load_dwordx4 v[160:163], v7, s[46:47] offset:1024 sc1
    s_waitcnt vmcnt(0)
    s_branch LC_final
LC_poll1x_retry:
    s_add_u32 s10, s10, 1
    s_cmp_ge_u32 s10, 40000
    s_cbranch_scc1 LC_poll1x_ok
    v_mov_b32 v241, 0
    global_load_dwordx2 v[244:245], v241, s[44:45] sc1
    s_mov_b64 exec, vcc
    global_load_dwordx4 v[232:235], v247, s[46:47] offset:0 sc1
    global_load_dwordx4 v[236:239], v247, s[46:47] offset:1024 sc1
    s_mov_b64 exec, -1
    s_waitcnt vmcnt(0)
    v_readfirstlane_b32 s66, v244
    v_readfirstlane_b32 s67, v245
    s_xor_b32 s67, s67, 1
    s_branch LC_poll1x
LC_poll1y_retry:
    s_add_u32 s10, s10, 1
    s_cmp_ge_u32 s10, 40000
    s_cbranch_scc1 LC_poll1y_ok
    v_mov_b32 v241, 0
    global_load_dwordx2 v[244:245], v241, s[44:45] sc1
    s_mov_b64 exec, vcc
    global_load_dwordx4 v[232:235], v247, s[46:47] offset:0 sc1
    global_load_dwordx4 v[236:239], v247, s[46:47] offset:1024 sc1
    s_mov_b64 exec, -1
    s_waitcnt vmcnt(0)
    v_readfirstlane_b32 s66, v244
    v_readfirstlane_b32 s67, v245
    s_xor_b32 s67, s67, 1
    s_branch LC_poll1y
L_moe:
    s_mul_i32 s62, s101, 7
    s_lshr_b32 s6, s5, 1
    s_add_u32 s62, s62, s6
    s_and_b32 s63, s5, 1
    s_lshl_b32 s6, s63, 3
    s_add_u32 s6, s6, s3
    s_lshl_b32 s6, s6, 6
    v_lshrrev_b32 v8, 4, v1
    v_and_b32 v9, 7, v1
    v_lshl_add_u32 v10, v8, 3, s6
    v_mul_u32_u24 v12, 7168, v10
    s_lshl_b32 s7, s62, 7
    v_lshl_add_u32 v13, v9, 4, s7
    v_add_u32 v12, v12, v13
    v_mov_b32 v13, 0
    s_mov_b32 s12, 0x00ff00ff
    s_mov_b32 s13, 0x00ff00ff
    s_load_dword s60, s[46:47], 61440
    v_mov_b32 v6, s36
    v_mov_b32 v7, s37
    v_mov_b32 v14, s34
    v_mov_b32 v15, s35
    v_cndmask_b32 v6, v6, v14, s[12:13]
    v_cndmask_b32 v7, v7, v15, s[12:13]
    v_lshl_add_u64 v[6:7], v[6:7], 0, v[12:13]
    s_lshl_b32 s6, s3, 4
    v_mov_b32 v44, s6
    v_lshlrev_b32 v45, 3, v1
    s_mov_b32 s8, 7168
    s_mov_b32 s9, 0
    s_mov_b32 s10, 179200
    s_mov_b32 s11, 0
    s_cmp_ge_u32 s5, 14
    s_cbranch_scc1 LM_spare0
    s_barrier
    global_load_dwordx4 v[64:67], v[6:7], off nt
    v_lshl_add_u64 v[6:7], s[8:9], 0, v[6:7]
    global_load_dwordx4 v[68:71], v[6:7], off nt
    v_lshl_add_u64 v[6:7], s[8:9], 0, v[6:7]
    v_mov_b32 v40, 0
    v_mov_b32 v41, 0
    v_mov_b32 v42, 0
    v_mov_b32 v43, 0
    s_waitcnt vmcnt(6)
    s_barrier
    ds_read_b128 v[144:147], v3 offset:16384
    ds_read_b128 v[148:151], v3 offset:17408
    ds_read_b128 v[152:155], v3 offset:18432
    ds_read_b128 v[156:159], v3 offset:19456
    s_waitcnt vmcnt(5) lgkmcnt(0)
    v_dot2_f32_bf16 v40, v128, v144, v40
    v_dot2_f32_bf16 v41, v128, v152, v41
    v_dot2_f32_bf16 v40, v129, v145, v40
    v_dot2_f32_bf16 v41, v129, v153, v41
    v_dot2_f32_bf16 v40, v130, v146, v40
    v_dot2_f32_bf16 v41, v130, v154, v41
    v_dot2_f32_bf16 v40, v131, v147, v40
    v_dot2_f32_bf16 v41, v131, v155, v41
    s_waitcnt vmcnt(4)
    v_dot2_f32_bf16 v40, v132, v148, v40
    v_dot2_f32_bf16 v41, v132, v156, v41
    v_dot2_f32_bf16 v40, v133, v149, v40
    v_dot2_f32_bf16 v41, v133, v157, v41
    v_dot2_f32_bf16 v40, v134, v150, v40
    v_dot2_f32_bf16 v41, v134, v158, v41
    v_dot2_f32_bf16 v40, v135, v151, v40
    v_dot2_f32_bf16 v41, v135, v159, v41
    s_waitcnt vmcnt(3)
    v_dot2_f32_bf16 v42, v136, v144, v42
    v_dot2_f32_bf16 v43, v136, v152, v43
    v_dot2_f32_bf16 v42, v137, v145, v42
    v_dot2_f32_bf16 v43, v137, v153, v43
    v_dot2_f32_bf16 v42, v138, v146, v42
    v_dot2_f32_bf16 v43, v138, v154, v43
    v_dot2_f32_bf16 v42, v139, v147, v42
    v_dot2_f32_bf16 v43, v139, v155, v43
    s_waitcnt vmcnt(2)
    global_load_dwordx4 v[72:75], v[6:7], off nt
    v_lshl_add_u64 v[6:7], s[8:9], 0, v[6:7]
    global_load_dwordx4 v[76:79], v[6:7], off nt
    v_lshl_add_u64 v[6:7], s[8:9], 0, v[6:7]
    s_branch LM_rows
LM_spare0:
    s_cmp_lg_u32 s2, 118
    s_cbranch_scc1 LM_spare1
    s_cmp_lg_u32 s3, 1
    s_cbranch_scc1 LM_spare1
    s_waitcnt lgkmcnt(0)
    s_add_u32 s6, s60, 0x9e3779b1
    v_mov_b32 v46, s6
    v_mov_b32 v47, 1
    v_mov_b32 v2, 0
    s_mov_b64 exec, 1
    global_store_dwordx2 v2, v[46:47], s[44:45] sc1
    s_mov_b64 exec, -1
LM_spare1:
    v_mov_b32 v40, 0
    v_mov_b32 v41, 0
    v_mov_b32 v42, 0
    v_mov_b32 v43, 0
    s_lshr_b32 s6, s34, 7
    s_mul_i32 s7, s101, 7
    s_add_u32 s6, s6, s7
    s_sub_u32 s6, 3, s6
    s_and_b32 s6, s6, 7
    s_cmp_eq_u32 s6, 7
    s_cselect_b32 s6, 0, s6
    s_add_u32 s6, s6, s7
    s_lshl_b32 s6, s6, 7
    v_and_b32 v2, 3, v1
    v_add_u32 v2, 4, v2
    v_and_b32 v12, 8, v2
    v_mul_u32_u24 v12, 3, v12
    v_add3_u32 v2, v2, v12, v10
    v_mul_u32_u24 v2, 7168, v2
    v_add_u32 v2, s6, v2
    s_barrier
    s_mov_b32 exec_lo, 0x000f000f
    s_mov_b32 exec_hi, 0x000f000f
    global_load_dword v60, v2, s[34:35]
    global_load_dword v61, v2, s[36:37]
    s_mov_b64 exec, -1
    s_waitcnt vmcnt(6)
    s_barrier
    ds_read_b128 v[144:147], v3 offset:16384
    ds_read_b128 v[148:151], v3 offset:17408
    ds_read_b128 v[152:155], v3 offset:18432
    ds_read_b128 v[156:159], v3 offset:19456
    s_waitcnt vmcnt(5) lgkmcnt(0)
    v_dot2_f32_bf16 v40, v128, v144, v40
    v_dot2_f32_bf16 v41, v128, v152, v41
    v_dot2_f32_bf16 v40, v129, v145, v40
    v_dot2_f32_bf16 v41, v129, v153, v41
    v_dot2_f32_bf16 v40, v130, v146, v40
    v_dot2_f32_bf16 v41, v130, v154, v41
    v_dot2_f32_bf16 v40, v131, v147, v40
    v_dot2_f32_bf16 v41, v131, v155, v41
    s_waitcnt vmcnt(4)
    v_dot2_f32_bf16 v40, v132, v148, v40
    v_dot2_f32_bf16 v41, v132, v156, v41
    v_dot2_f32_bf16 v40, v133, v149, v40
    v_dot2_f32_bf16 v41, v133, v157, v41
    v_dot2_f32_bf16 v40, v134, v150, v40
    v_dot2_f32_bf16 v41, v134, v158, v41
    v_dot2_f32_bf16 v40, v135, v151, v40
    v_dot2_f32_bf16 v41, v135, v159, v41
    s_waitcnt vmcnt(3)
    v_dot2_f32_bf16 v42, v136, v144, v42
    v_dot2_f32_bf16 v43, v136, v152, v43
    v_dot2_f32_bf16 v42, v137, v145, v42
    v_dot2_f32_bf16 v43, v137, v153, v43
    v_dot2_f32_bf16 v42, v138, v146, v42
    v_dot2_f32_bf16 v43, v138, v154, v43
    v_dot2_f32_bf16 v42, v139, v147, v42
    v_dot2_f32_bf16 v43, v139, v155, v43
    s_waitcnt vmcnt(2)
LM_rows:
    v_dot2_f32_bf16 v42, v140, v148, v42
    v_dot2_f32_bf16 v43, v140, v156, v43
    v_dot2_f32_bf16 v42, v141, v149, v42
    v_dot2_f32_bf16 v43, v141, v157, v43
    v_dot2_f32_bf16 v42, v142, v150, v42
    v_dot2_f32_bf16 v43, v142, v158, v43
    v_dot2_f32_bf16 v42, v143, v151, v42
    v_dot2_f32_bf16 v43, v143, v159, v43
    s_add_u32 s60, s60, 0x9e3779b1
    s_getreg_b32 s61, hwreg(HW_REG_XCC_ID, 0, 4)
    v_add_f32_dpp v40, v40, v40 row_shr:1 row_mask:0xf bank_mask:0xf bound_ctrl:0
    v_add_f32_dpp v41, v41, v41 row_shr:1 row_mask:0xf bank_mask:0xf bound_ctrl:0
    v_add_f32_dpp v42, v42, v42 row_shr:1 row_mask:0xf bank_mask:0xf bound_ctrl:0
    v_add_f32_dpp v43, v43, v43 row_shr:1 row_mask:0xf bank_mask:0xf bound_ctrl:0
    v_add_f32_dpp v40, v40, v40 row_shr:2 row_mask:0xf bank_mask:0xf bound_ctrl:0
    v_add_f32_dpp v41, v41, v41 row_shr:2 row_mask:0xf bank_mask:0xf bound_ctrl:0
    v_add_f32_dpp v42, v42, v42 row_shr:2 row_mask:0xf bank_mask:0xf bound_ctrl:0
    v_add_f32_dpp v43, v43, v43 row_shr:2 row_mask:0xf bank_mask:0xf bound_ctrl:0
    v_add_f32_dpp v40, v40, v40 row_shr:4 row_mask:0xf bank_mask:0xf bound_ctrl:0
    v_add_f32_dpp v41, v41, v41 row_shr:4 row_mask:0xf bank_mask:0xf bound_ctrl:0
    v_add_f32_dpp v42, v42, v42 row_shr:4 row_mask:0xf bank_mask:0xf bound_ctrl:0
    v_add_f32_dpp v43, v43, v43 row_shr:4 row_mask:0xf bank_mask:0xf bound_ctrl:0
    v_add_f32_dpp v40, v40, v40 row_shr:8 row_mask:0xf bank_mask:0xf bound_ctrl:0
    v_add_f32_dpp v41, v41, v41 row_shr:8 row_mask:0xf bank_mask:0xf bound_ctrl:0
    v_add_f32_dpp v42, v42, v42 row_shr:8 row_mask:0xf bank_mask:0xf bound_ctrl:0
    v_add_f32_dpp v43, v43, v43 row_shr:8 row_mask:0xf bank_mask:0xf bound_ctrl:0
    v_add_f32_dpp v40, v40, v40 row_bcast:15 row_mask:0xa bank_mask:0xf
    v_add_f32_dpp v41, v41, v41 row_bcast:15 row_mask:0xa bank_mask:0xf
    v_add_f32_dpp v42, v42, v42 row_bcast:15 row_mask:0xa bank_mask:0xf
    v_add_f32_dpp v43, v43, v43 row_bcast:15 row_mask:0xa bank_mask:0xf
    v_add_f32_dpp v40, v40, v40 row_bcast:31 row_mask:0xc bank_mask:0xf
    v_add_f32_dpp v41, v41, v41 row_bcast:31 row_mask:0xc bank_mask:0xf
    v_add_f32_dpp v42, v42, v42 row_bcast:31 row_mask:0xc bank_mask:0xf
    v_add_f32_dpp v43, v43, v43 row_bcast:31 row_mask:0xc bank_mask:0xf
    s_mov_b32 exec_lo, 0
    s_mov_b32 exec_hi, 0x80000000
    ds_write_b128 v44, v[40:43] offset:0
    s_mov_b64 exec, -1
    s_waitcnt lgkmcnt(0)
    s_barrier
    s_cmp_lg_u32 s3, 0
    s_cbranch_scc1 LM_nopub
    ds_read_b64 v[46:47], v45 offset:0
    s_lshl_b32 s6, s2, 7
    s_add_u32 s6, s6, 65536
    v_add_u32 v2, s6, v45
    s_add_u32 s6, s6, 131072
    v_writelane_b32 v2, s6, 16
    v_mov_b32 v48, s61
    v_mov_b32 v49, s60
    s_mov_b32 s6, 0x07060100
    s_mov_b64 exec, 0xffff
    s_waitcnt lgkmcnt(0)
    v_cvt_pk_bf16_f32 v46, v47, v46
    v_lshlrev_b32 v47, 16, v46
    v_mul_f32 v47, 0xbfb8aa3b, v47
    v_exp_f32 v47, v47
    v_ashrrev_i32 v50, 31, v46
    v_add_f32 v47, 1.0, v47
    v_rcp_f32 v47, v47
    v_or_b32 v50, 0x80000000, v50
    v_cvt_pk_bf16_f32 v47, v47, v47
    v_xor_b32 v46, v46, v50
    v_perm_b32 v48, v46, v47, s6
    s_mov_b64 exec, 0x1ffff
    global_store_dwordx2 v2, v[48:49], s[46:47] sc1
    s_mov_b64 exec, -1
LM_nopub:
    s_cmp_ge_u32 s5, 14
    s_cbranch_scc1 LM_spare
    s_barrier
    global_load_dwordx4 v[80:83], v[6:7], off nt
    v_lshl_add_u64 v[6:7], s[8:9], 0, v[6:7]
    global_load_dwordx4 v[84:87], v[6:7], off nt
    v_lshl_add_u64 v[6:7], s[8:9], 0, v[6:7]
    s_mov_b32 s48, s16
    s_mov_b32 s49, s17
    s_mov_b32 s50, 4194304
    s_mov_b32 s51, 0x00020000
    s_mov_b32 s56, s38
    s_mov_b32 s57, s39
    s_mov_b32 s58, 7340032
    s_mov_b32 s59, 0x00020000
    v_mov_b32 v12, 0
    v_lshlrev_b32 v13, 2, v1
    ds_write_b32 v13, v12 offset:1536
    s_lshl_b32 s6, s3, 9
    v_lshl_add_u32 v14, v1, 3, s6
    s_mov_b32 s64, 0x05040100
    s_mov_b32 s65, 0x07060302
    v_lshrrev_b32 v56, 5, v1
    v_bfe_u32 v57, v1, 4, 1
    v_bfe_u32 v58, v1, 3, 1
    v_lshlrev_b32 v2, 2, v56
    v_xor_b32 v2, v2, v9
    v_lshrrev_b32 v59, 3, v1
    v_lshlrev_b32 v59, 11, v59
    v_lshl_add_u32 v42, v2, 4, v59
    v_xor_b32 v43, 32, v42
    s_lshl_b32 s70, s62, 17
    s_lshl_b32 s7, s63, 10
    s_add_u32 s70, s70, s7
    s_lshl_b32 s7, s3, 7
    s_add_u32 s70, s70, s7
    s_lshl_b32 s71, s3, 13
    s_add_u32 s71, s71, 49152
    v_bfe_u32 v59, v1, 2, 1
    v_lshlrev_b32 v2, 11, v56
    v_lshl_add_u32 v2, v57, 9, v2
    v_lshl_add_u32 v2, v58, 7, v2
    v_lshl_add_u32 v2, v59, 10, v2
    v_lshl_add_u32 v2, v59, 5, v2
    v_lshl_add_u32 v2, v57, 6, v2
    v_and_b32 v59, 3, v1
    v_lshl_add_u32 v2, v59, 3, v2
    v_add_u32 v44, s71, v2
    v_xor_b32 v45, 32, v44
    v_xor_b32 v46, 64, v44
    v_xor_b32 v47, 96, v44
    s_and_b32 s6, s3, 3
    s_lshr_b32 s7, s3, 2
    s_lshl_b32 s15, s6, 1
    s_add_u32 s15, s15, s7
    s_lshl_b32 s15, s15, 9
    s_add_u32 s15, s15, 16384
    v_add_u32 v48, s15, v13
    s_lshl_b32 s7, s7, 3
    s_add_u32 s6, s6, s7
    s_lshl_b32 s6, s6, 2
    v_mul_u32_u24 v2, 144, v9
    v_lshl_add_u32 v51, v57, 6, v2
    v_lshl_add_u32 v51, v58, 4, v51
    v_lshl_add_u32 v51, v56, 1, v51
    v_add_u32 v51, s6, v51
    v_lshl_add_u32 v2, v8, 4, v2
    v_mov_b32 v59, 1280
    v_cndmask_b32 v52, v59, v2, s[12:13]
    v_cndmask_b32 v53, v2, v59, s[12:13]
    s_lshl_b32 s6, s62, 1
    s_add_u32 s6, s6, s63
    s_lshl_b32 s6, s6, 12
    s_add_u32 s6, s6, 1048576
    v_add_u32 v49, s6, v14
    v_xor_b32 v50, 4096, v49
    s_lshl_b32 s6, s63, 3
    s_add_u32 s6, s6, s3
    s_lshl_b32 s6, s6, 17
    s_lshl_b32 s7, s62, 8
    s_add_u32 s6, s6, s7
    s_add_u32 s6, s6, 2097152
    v_lshl_add_u32 v11, v56, 15, s6
    v_lshl_add_u32 v11, v58, 14, v11
    v_lshl_add_u32 v11, v57, 7, v11
    v_lshl_add_u32 v11, v9, 4, v11
    v_add_u32 v4, 0x10000, v11
    s_bfe_u32 s6, s60, 0x80000
    v_mov_b32 v34, s6
    s_bfe_u32 s6, s60, 0x80008
    v_mov_b32 v35, s6
    s_bfe_u32 s6, s60, 0x80010
    v_mov_b32 v61, s6
    s_bfe_u32 s6, s60, 0x80018
    v_mov_b32 v13, s6
    s_mov_b32 vcc_lo, 0xaaaaaaaa
    s_mov_b32 vcc_hi, 0xaaaaaaaa
    v_cndmask_b32 v0, v34, v61, vcc
    v_cndmask_b32 v63, v35, v13, vcc
    s_lshl_b32 s6, s63, 3
    s_add_u32 s6, s6, s4
    s_lshl_b32 s6, s6, 8
    s_add_u32 s6, s6, 163840
    v_lshl_add_u32 v5, v9, 3, s6
    s_lshl_b32 s66, s2, 9
    s_add_u32 s66, s66, 262144
    v_lshl_add_u32 v15, v9, 3, s66
    v_mov_b32 v60, 0x7ffffff0
    s_mov_b32 s14, 0
    global_load_dwordx4 v[88:91], v[6:7], off nt
    v_lshl_add_u64 v[6:7], s[8:9], 0, v[6:7]
    global_load_dwordx4 v[92:95], v[6:7], off nt
    v_lshl_add_u64 v[6:7], s[10:11], 0, v[6:7]
    global_load_dwordx4 v[96:99], v[6:7], off nt
    v_lshl_add_u64 v[6:7], s[8:9], 0, v[6:7]
    global_load_dwordx4 v[100:103], v[6:7], off nt
    v_lshl_add_u64 v[6:7], s[8:9], 0, v[6:7]
    global_load_dwordx4 v[104:107], v[6:7], off nt
    v_lshl_add_u64 v[6:7], s[8:9], 0, v[6:7]
    global_load_dwordx4 v[108:111], v[6:7], off nt
    v_lshl_add_u64 v[6:7], s[8:9], 0, v[6:7]
    global_load_dwordx2 v[54:55], v50, s[46:47] sc1
    s_barrier
    s_lshl_b32 s11, s3, 12
    s_add_u32 s11, s11, 16384
    s_mov_b32 s10, 0xffffff00
    s_waitcnt vmcnt(9)
    v_perm_b32 v128, v68, v64, s64
    v_perm_b32 v129, v76, v72, s64
    v_perm_b32 v132, v68, v64, s65
    v_perm_b32 v133, v76, v72, s65
    v_perm_b32 v136, v69, v65, s64
    v_perm_b32 v137, v77, v73, s64
    v_perm_b32 v140, v69, v65, s65
    v_perm_b32 v141, v77, v73, s65
    v_perm_b32 v144, v70, v66, s64
    v_perm_b32 v145, v78, v74, s64
    v_perm_b32 v148, v70, v66, s65
    v_perm_b32 v149, v78, v74, s65
    v_perm_b32 v152, v71, v67, s64
    v_perm_b32 v153, v79, v75, s64
    v_perm_b32 v156, v71, v67, s65
    v_perm_b32 v157, v79, v75, s65
    global_load_dwordx4 v[112:115], v[6:7], off nt
    v_lshl_add_u64 v[6:7], s[8:9], 0, v[6:7]
    global_load_dwordx4 v[116:119], v[6:7], off nt
    v_lshl_add_u64 v[6:7], s[8:9], 0, v[6:7]
    global_load_dwordx4 v[120:123], v[6:7], off nt
    v_lshl_add_u64 v[6:7], s[8:9], 0, v[6:7]
    global_load_dwordx4 v[124:127], v[6:7], off nt
    s_barrier
LM_try:
    s_load_dwordx16 s[16:31], s[46:47], s66
    s_add_u32 s66, s66, 64
    s_waitcnt lgkmcnt(0)
    s_xor_b32 s6, s17, s60
    s_xor_b32 s7, s19, s60
    s_or_b32 s6, s6, s7
    s_xor_b32 s7, s21, s60
    s_or_b32 s6, s6, s7
    s_xor_b32 s7, s23, s60
    s_or_b32 s6, s6, s7
    s_xor_b32 s7, s25, s60
    s_or_b32 s6, s6, s7
    s_xor_b32 s7, s27, s60
    s_or_b32 s6, s6, s7
    s_xor_b32 s7, s29, s60
    s_or_b32 s6, s6, s7
    s_xor_b32 s7, s31, s60
    s_or_b32 s6, s6, s7
    s_cbranch_scc1 LM_try_again
    s_mov_b32 exec_lo, 0x01010101
    s_mov_b32 exec_hi, 0x01010101
    v_not_b32 v38, s16
    s_lshl_b64 exec, exec, 1
    v_not_b32 v38, s18
    s_lshl_b64 exec, exec, 1
    v_not_b32 v38, s20
    s_lshl_b64 exec, exec, 1
    v_not_b32 v38, s22
    s_lshl_b64 exec, exec, 1
    v_not_b32 v38, s24
    s_lshl_b64 exec, exec, 1
    v_not_b32 v38, s26
    s_lshl_b64 exec, exec, 1
    v_not_b32 v38, s28
    s_lshl_b64 exec, exec, 1
    v_not_b32 v38, s30
    s_mov_b64 exec, -1
LM_keys:
    v_and_b32 v39, 2047, v38
    v_lshlrev_b32 v38, 11, v39
    v_lshl_add_u32 v38, v10, 1, v38
    v_cndmask_b32 v40, v60, v38, s[12:13]
    v_cndmask_b32 v41, v38, v60, s[12:13]
    buffer_load_dwordx4 v[224:227], v40, s[48:51], 0 offen
    buffer_load_dwordx4 v[236:239], v41, s[48:51], 0 offen offset:64
    s_mov_b32 s61, s16
    s_barrier
    s_add_u32 m0, s71, 0
    s_add_u32 s7, s70, 0
    buffer_load_dwordx4 v42, s[56:59], s7 offen lds
    s_add_u32 m0, s71, 1024
    s_add_u32 s7, s70, 16384
    buffer_load_dwordx4 v43, s[56:59], s7 offen lds
    s_add_u32 m0, s71, 2048
    s_add_u32 s7, s70, 32768
    buffer_load_dwordx4 v42, s[56:59], s7 offen lds
    s_add_u32 m0, s71, 3072
    s_add_u32 s7, s70, 49152
    buffer_load_dwordx4 v43, s[56:59], s7 offen lds
    global_load_dwordx2 v[32:33], v5, s[46:47] offset:128 sc1
    s_mov_b32 m0, s11
    s_waitcnt vmcnt(11)
    v_perm_b32 v130, v84, v80, s64
    v_perm_b32 v131, v92, v88, s64
    v_perm_b32 v134, v84, v80, s65
    v_perm_b32 v135, v92, v88, s65
    v_perm_b32 v138, v85, v81, s64
    v_perm_b32 v139, v93, v89, s64
    v_perm_b32 v142, v85, v81, s65
    v_perm_b32 v143, v93, v89, s65
    v_perm_b32 v146, v86, v82, s64
    v_perm_b32 v147, v94, v90, s64
    v_perm_b32 v150, v86, v82, s65
    v_perm_b32 v151, v94, v90, s65
    v_perm_b32 v154, v87, v83, s64
    v_perm_b32 v155, v95, v91, s64
    v_perm_b32 v158, v87, v83, s65
    v_perm_b32 v159, v95, v91, s65
    v_perm_b32 v160, v100, v96, s64
    v_perm_b32 v161, v108, v104, s64
    v_perm_b32 v164, v100, v96, s65
    v_perm_b32 v165, v108, v104, s65
    v_perm_b32 v168, v101, v97, s64
    v_perm_b32 v169, v109, v105, s64
    v_perm_b32 v172, v101, v97, s65
    v_perm_b32 v173, v109, v105, s65
    v_perm_b32 v176, v102, v98, s64
    v_perm_b32 v177, v110, v106, s64
    v_perm_b32 v180, v102, v98, s65
    v_perm_b32 v181, v110, v106, s65
    v_perm_b32 v184, v103, v99, s64
    v_perm_b32 v185, v111, v107, s64
    v_perm_b32 v188, v103, v99, s65
    v_perm_b32 v189, v111, v107, s65
    s_waitcnt vmcnt(9)
    v_perm_b32 v162, v116, v112, s64
    v_perm_b32 v166, v116, v112, s65
    v_perm_b32 v170, v117, v113, s64
    v_perm_b32 v174, v117, v113, s65
    v_perm_b32 v178, v118, v114, s64
    v_perm_b32 v182, v118, v114, s65
    v_perm_b32 v186, v119, v115, s64
    v_perm_b32 v190, v119, v115, s65
    s_waitcnt vmcnt(5)
LM_mf:
    v_mfma_f32_16x16x32_bf16 v[240:243], v[128:131], v[224:227], 0
    v_mov_b32_dpp v228, v224 row_shr:8 row_mask:0xf bank_mask:0xf bound_ctrl:0
    v_mov_b32_dpp v229, v225 row_shr:8 row_mask:0xf bank_mask:0xf bound_ctrl:0
    v_mfma_f32_16x16x32_bf16 v[244:247], v[132:135], v[224:227], 0
    v_mov_b32_dpp v230, v226 row_shr:8 row_mask:0xf bank_mask:0xf bound_ctrl:0
    v_mov_b32_dpp v231, v227 row_shr:8 row_mask:0xf bank_mask:0xf bound_ctrl:0
    v_mfma_f32_16x16x32_bf16 v[248:251], v[136:139], v[224:227], 0
    v_mov_b32_dpp v232, v236 row_shl:8 row_mask:0xf bank_mask:0xf bound_ctrl:0
    v_mov_b32_dpp v233, v237 row_shl:8 row_mask:0xf bank_mask:0xf bound_ctrl:0
    v_mfma_f32_16x16x32_bf16 v[252:255], v[140:143], v[224:227], 0
    v_mov_b32_dpp v234, v238 row_shl:8 row_mask:0xf bank_mask:0xf bound_ctrl:0
    v_mov_b32_dpp v235, v239 row_shl:8 row_mask:0xf bank_mask:0xf bound_ctrl:0
    v_mfma_f32_16x16x32_bf16 v[240:243], v[144:147], v[228:231], v[240:243]
    v_perm_b32 v179, v126, v122, s64
    v_perm_b32 v163, v124, v120, s64
    v_mfma_f32_16x16x32_bf16 v[244:247], v[148:151], v[228:231], v[244:247]
    v_perm_b32 v183, v126, v122, s65
    v_perm_b32 v167, v124, v120, s65
    v_mfma_f32_16x16x32_bf16 v[248:251], v[152:155], v[228:231], v[248:251]
    v_perm_b32 v187, v127, v123, s64
    v_perm_b32 v171, v125, v121, s64
    v_mfma_f32_16x16x32_bf16 v[252:255], v[156:159], v[228:231], v[252:255]
    v_perm_b32 v191, v127, v123, s65
    v_perm_b32 v175, v125, v121, s65
    v_mfma_f32_16x16x32_bf16 v[240:243], v[176:179], v[236:239], v[240:243]
    v_mfma_f32_16x16x32_bf16 v[240:243], v[160:163], v[232:235], v[240:243]
    s_nop 1
    v_mfma_f32_16x16x32_bf16 v[244:247], v[180:183], v[236:239], v[244:247]
    s_nop 1
    v_mfma_f32_16x16x32_bf16 v[244:247], v[164:167], v[232:235], v[244:247]
    s_nop 1
    v_mfma_f32_16x16x32_bf16 v[248:251], v[184:187], v[236:239], v[248:251]
    ds_write_addtid_b32 v240 offset:0
    ds_write_addtid_b32 v241 offset:256
    v_mfma_f32_16x16x32_bf16 v[248:251], v[168:171], v[232:235], v[248:251]
    ds_write_addtid_b32 v242 offset:512
    ds_write_addtid_b32 v243 offset:768
    v_mfma_f32_16x16x32_bf16 v[252:255], v[188:191], v[236:239], v[252:255]
    ds_write_addtid_b32 v244 offset:1024
    ds_write_addtid_b32 v245 offset:1280
    v_mfma_f32_16x16x32_bf16 v[252:255], v[172:175], v[232:235], v[252:255]
    ds_write_addtid_b32 v246 offset:1536
    ds_write_addtid_b32 v247 offset:1792
    ds_write_addtid_b32 v248 offset:2048
    ds_write_addtid_b32 v249 offset:2304
    ds_write_addtid_b32 v250 offset:2560
    ds_write_addtid_b32 v251 offset:2816
    s_nop 1
    ds_write_addtid_b32 v252 offset:3072
    ds_write_addtid_b32 v253 offset:3328
    ds_write_addtid_b32 v254 offset:3584
    ds_write_addtid_b32 v255 offset:3840
    s_waitcnt lgkmcnt(0)
    s_barrier
    ds_read2st64_b32 v[64:65], v48 offset0:0 offset1:1
    ds_read2st64_b32 v[66:67], v48 offset0:16 offset1:17
    ds_read2st64_b32 v[68:69], v48 offset0:32 offset1:33
    ds_read2st64_b32 v[70:71], v48 offset0:48 offset1:49
    ds_read2st64_b32 v[72:73], v48 offset0:64 offset1:65
    ds_read2st64_b32 v[74:75], v48 offset0:80 offset1:81
    ds_read2st64_b32 v[76:77], v48 offset0:96 offset1:97
    ds_read2st64_b32 v[78:79], v48 offset0:112 offset1:113
    s_bitcmp0_b32 s61, 11
    s_waitcnt lgkmcnt(4)
    v_pk_add_f32 v[64:65], v[64:65], v[66:67]
    v_pk_add_f32 v[68:69], v[68:69], v[70:71]
    s_waitcnt lgkmcnt(2)
    v_pk_add_f32 v[72:73], v[72:73], v[74:75]
    v_pk_add_f32 v[64:65], v[64:65], v[68:69]
    s_waitcnt lgkmcnt(0)
    v_pk_add_f32 v[76:77], v[76:77], v[78:79]
    v_pk_add_f32 v[64:65], v[64:65], v[72:73]
    v_pk_add_f32 v[128:129], v[64:65], v[76:77]
    v_and_or_b32 v130, v128, s10, v0
    v_and_or_b32 v131, v129, s10, v63
    s_cbranch_scc1 LM_far
    global_store_dwordx2 v49, v[130:131], s[46:47]
LM_sent:
    s_barrier
    s_add_u32 m0, s71, 4096
    s_add_u32 s7, s70, 65536
    buffer_load_dwordx4 v42, s[56:59], s7 offen lds
    s_add_u32 m0, s71, 5120
    s_add_u32 s7, s70, 81920
    buffer_load_dwordx4 v43, s[56:59], s7 offen lds
    s_mov_b32 s14, 0
    s_waitcnt vmcnt(2)
    global_load_dwordx2 v[54:55], v50, s[46:47] sc1
    s_add_u32 m0, s71, 6144
    s_add_u32 s7, s70, 98304
    buffer_load_dwordx4 v42, s[56:59], s7 offen lds
    s_add_u32 m0, s71, 7168
    s_add_u32 s7, s70, 114688
    buffer_load_dwordx4 v43, s[56:59], s7 offen lds
    s_waitcnt vmcnt(5)
    ds_read_b64_tr_b16 v[192:193], v44 offset:0
    ds_read_b64_tr_b16 v[194:195], v44 offset:256
    ds_read_b64_tr_b16 v[196:197], v45 offset:0
    ds_read_b64_tr_b16 v[198:199], v45 offset:256
    ds_read_b64_tr_b16 v[200:201], v46 offset:0
    ds_read_b64_tr_b16 v[202:203], v46 offset:256
    ds_read_b64_tr_b16 v[204:205], v47 offset:0
    ds_read_b64_tr_b16 v[206:207], v47 offset:256
    s_waitcnt vmcnt(2)
LM_poll2:
    v_xor_b32 v56, v0, v54
    v_xor_b32 v57, v63, v55
    v_bitop3_b32 v2, v56, v57, s10 bitop3:0x54
    v_bitop3_b32 v2, v33, s60, v2 bitop3:0xbe
    v_cmp_ne_u32 vcc, 0, v2
    s_cbranch_vccnz LM_poll2_retry
LM_poll2_ok:
    v_pk_add_f32 v[54:55], v[56:57], v[128:129]
    s_nop 1
    v_permlane32_swap_b32 v54, v55
    v_cvt_pk_bf16_f32 v55, v54, v55
    v_lshlrev_b32 v54, 16, v55
    v_mul_f32 v56, 0xbfb8aa3b, v54
    v_exp_f32 v56, v56
    v_and_b32 v55, 0xffff0000, v55
    v_add_f32 v56, 1.0, v56
    v_rcp_f32 v56, v56
    v_mul_f32 v55, v55, v32
    v_mul_f32 v54, v54, v56
    v_mul_f32 v54, v54, v55
    v_cvt_pk_bf16_f32 v54, v54, v54
    ds_write_b16 v51, v54 offset:256
    s_waitcnt vmcnt(0)
    ds_read_b64_tr_b16 v[208:209], v44 offset:4096
    ds_read_b64_tr_b16 v[210:211], v44 offset:4352
    ds_read_b64_tr_b16 v[212:213], v45 offset:4096
    ds_read_b64_tr_b16 v[214:215], v45 offset:4352
    ds_read_b64_tr_b16 v[216:217], v46 offset:4096
    ds_read_b64_tr_b16 v[218:219], v46 offset:4352
    ds_read_b64_tr_b16 v[220:221], v47 offset:4096
    ds_read_b64_tr_b16 v[222:223], v47 offset:4352
    s_waitcnt lgkmcnt(8)
    s_barrier
    ds_read_b128 v[224:227], v52 offset:256
    ds_read_b128 v[228:231], v53 offset:256
    ds_read_b128 v[232:235], v52 offset:320
    ds_read_b128 v[236:239], v53 offset:320
    s_waitcnt lgkmcnt(3)
    v_mfma_f32_16x16x32_bf16 v[240:243], v[224:227], v[192:195], 0
    s_waitcnt lgkmcnt(2)
    v_mfma_f32_16x16x32_bf16 v[240:243], v[228:231], v[196:199], v[240:243]
    s_waitcnt lgkmcnt(1)
    v_mfma_f32_16x16x32_bf16 v[240:243], v[232:235], v[208:211], v[240:243]
    s_waitcnt lgkmcnt(0)
    v_mfma_f32_16x16x32_bf16 v[240:243], v[236:239], v[212:215], v[240:243]
    v_mfma_f32_16x16x32_bf16 v[244:247], v[224:227], v[200:203], 0
    s_nop 1
    v_mfma_f32_16x16x32_bf16 v[244:247], v[228:231], v[204:207], v[244:247]
    s_nop 1
    v_mfma_f32_16x16x32_bf16 v[244:247], v[232:235], v[216:219], v[244:247]
    v_mfma_f32_16x16x32_bf16 v[244:247], v[236:239], v[220:223], v[244:247]
    v_and_or_b32 v240, v240, s10, v34
    v_and_or_b32 v241, v241, s10, v35
    v_and_or_b32 v242, v242, s10, v61
    v_and_or_b32 v243, v243, s10, v13
    global_store_dwordx4 v11, v[240:243], s[46:47] sc1
    s_nop 2
    v_and_or_b32 v244, v244, s10, v34
    v_and_or_b32 v245, v245, s10, v35
    v_and_or_b32 v246, v246, s10, v61
    v_and_or_b32 v247, v247, s10, v13
    global_store_dwordx4 v4, v[244:247], s[46:47] sc1
    s_endpgm
LM_far:
    global_store_dwordx2 v49, v[130:131], s[46:47] sc1
    s_branch LM_sent
LM_poll2_retry:
    s_add_u32 s14, s14, 1
    s_cmp_ge_u32 s14, 40000
    s_cbranch_scc1 LM_poll2_ok
    global_load_dwordx2 v[32:33], v5, s[46:47] offset:128 sc1
    global_load_dwordx2 v[54:55], v50, s[46:47] sc1
    s_waitcnt vmcnt(0)
    s_branch LM_poll2
LM_try_again:
    s_add_u32 s14, s14, 1
    s_cmp_ge_u32 s14, 8
    s_cbranch_scc1 LM_poll1
    s_branch LM_try
LM_poll1:
    global_load_dwordx2 v[36:37], v15, s[46:47] sc1
    s_add_u32 s14, s14, 1
    s_cmp_ge_u32 s14, 40000
    s_waitcnt vmcnt(0)
    v_cmp_ne_u32 vcc, s60, v37
    v_not_b32 v38, v36
    v_readfirstlane_b32 s16, v36
    s_cbranch_scc1 LM_keys
    s_cbranch_vccnz LM_poll1
    s_branch LM_keys
LM_spare:
    s_lshl_b32 s6, s3, 8
    s_sub_u32 s6, 2047, s6
    v_lshlrev_b32 v2, 1, v1
    v_sub_u32 v28, s6, v2
    v_subrev_u32 v29, 1, v28
    v_subrev_u32 v30, 0x80, v28
    v_subrev_u32 v31, 0x81, v28
    s_lshl_b32 s6, s3, 10
    v_add_u32 v14, s6, v3
    s_add_u32 s6, s6, 8192
    v_lshl_add_u32 v15, v1, 3, s6
    s_lshl_b32 s6, s3, 11
    s_add_u32 s6, s6, 65536
    v_add_u32 v5, s6, v3
    s_lshl_b32 s6, s4, 7
    s_add_u32 s6, s6, 196608
    v_min_u32 v59, 13, v1
    v_lshl_add_u32 v59, v59, 10, s6
    s_sub_u32 s70, s2, 112
    s_lshl_b32 s70, s70, 8
    s_add_u32 s70, s70, 163840
    s_mov_b32 s66, 0xffff0000
    s_mov_b32 s14, 0
    s_lshl_b32 s6, s63, 3
    s_add_u32 s6, s6, s4
    s_lshl_b32 s6, s6, 9
    s_add_u32 s6, s6, 262144
    v_lshl_add_u32 v50, v8, 13, s6
    v_and_b32 v2, 15, v1
    v_lshl_add_u32 v50, v2, 4, v50
    v_add_u32 v51, 0x8000, v50
    v_and_b32 v52, 3, v1
    v_lshlrev_b32 v52, 3, v52
    s_cmp_lg_u32 s3, 1
    s_cbranch_scc1 LA_nopw
    global_load_dword v13, v50, s[46:47] offset:0 sc1
    global_load_dword v13, v50, s[46:47] offset:256 sc1
    s_mov_b32 exec_hi, 0xffff
    global_load_dword v13, v51, s[46:47] offset:0 sc1
    global_load_dword v13, v51, s[46:47] offset:256 sc1
    s_mov_b32 exec_hi, -1
LA_nopw:
    s_waitcnt vmcnt(0)
    s_barrier
LA_poll:
    global_load_dwordx2 v[56:57], v59, s[46:47] sc1
    global_load_dwordx4 v[16:19], v5, s[46:47] offset:0 sc1
    global_load_dwordx4 v[20:23], v5, s[46:47] offset:1024 sc1
    s_mov_b64 exec, -1
    s_add_u32 s14, s14, 1
    s_cmp_ge_u32 s14, 40000
    s_waitcnt vmcnt(0)
    v_xor_b32 v2, s60, v57
    v_bitop3_b32 v2, v17, s60, v2 bitop3:0xbe
    v_bitop3_b32 v2, v19, s60, v2 bitop3:0xbe
    v_bitop3_b32 v2, v21, s60, v2 bitop3:0xbe
    v_bitop3_b32 v2, v23, s60, v2 bitop3:0xbe
    v_cmp_ne_u32 vcc, 0, v2
    s_cbranch_scc1 LA_poll_ok
    s_cbranch_vccz LA_poll_ok
    s_mov_b64 exec, vcc
    s_branch LA_poll
LA_poll_ok:
    v_and_or_b32 v24, v16, s66, v28
    v_and_or_b32 v25, v18, s66, v29
    v_and_or_b32 v26, v20, s66, v30
    v_and_or_b32 v27, v22, s66, v31
    v_max_u32 v40, v24, v25
    v_min_u32 v41, v24, v25
    v_max3_u32 v36, v40, v26, v27
    v_med3_u32 v42, v40, v26, v27
    v_min3_u32 v43, v40, v26, v27
    v_max_u32 v37, v42, v41
    v_med3_u32 v38, v42, v43, v41
    ds_write_b128 v14, v[36:39] offset:16384
    ds_write2_b32 v15, v16, v18 offset0:0 offset1:1
    ds_write2_b32 v15, v20, v22 offset0:128 offset1:129
    v_cmp_ne_u32 s[64:65], s61, v56
    s_cmp_lg_u32 s3, 0
    s_waitcnt lgkmcnt(2)
    s_barrier
    s_cbranch_scc1 LA_rest
    ds_read_b128 v[68:71], v3 offset:17408
    ds_read_b128 v[72:75], v3 offset:18432
    ds_read_b128 v[76:79], v3 offset:19456
    ds_read_b128 v[80:83], v3 offset:20480
    ds_read_b128 v[84:87], v3 offset:21504
    ds_read_b128 v[88:91], v3 offset:22528
    ds_read_b128 v[92:95], v3 offset:23552
    s_cmp_eq_u64 s[64:65], 0
    s_cselect_b32 s71, 0x800, 0
    v_mov_b32 v45, s60
    v_mov_b32 v47, s60
    v_mov_b32 v49, s60
    v_mov_b32 v55, s60
    s_waitcnt lgkmcnt(5)
    v_max3_u32 v40, v36, v68, v72
    v_med3_u32 v38, v37, v38, v68
    v_med3_u32 v37, v36, v37, v68
    v_max_u32 v36, v36, v68
    v_med3_u32 v38, v37, v38, v69
    v_max_u32 v37, v37, v69
    s_waitcnt lgkmcnt(0)
    v_max3_u32 v41, v76, v80, v84
    v_max3_u32 v40, v40, v88, v92
    v_max_u32 v40, v40, v41
    v_med3_u32 v38, v37, v38, v72
    v_med3_u32 v37, v36, v37, v72
    v_max_u32 v36, v36, v72
    v_med3_u32 v38, v37, v38, v73
    v_max_u32_dpp v40, v40, v40 quad_perm:[1,0,3,2] row_mask:0xf bank_mask:0xf
    v_max_u32 v37, v37, v73
    v_med3_u32 v38, v37, v38, v76
    v_med3_u32 v37, v36, v37, v76
    v_max_u32 v36, v36, v76
    v_max_u32_dpp v40, v40, v40 quad_perm:[2,3,0,1] row_mask:0xf bank_mask:0xf
    v_med3_u32 v38, v37, v38, v77
    v_max_u32 v37, v37, v77
    v_med3_u32 v38, v37, v38, v80
    v_med3_u32 v37, v36, v37, v80
    v_max_u32_dpp v40, v40, v40 row_half_mirror row_mask:0xf bank_mask:0xf
    v_max_u32 v36, v36, v80
    v_med3_u32 v38, v37, v38, v81
    v_max_u32 v37, v37, v81
    v_med3_u32 v38, v37, v38, v84
    v_min_u32_dpp v41, v40, v40 row_mirror row_mask:0xf bank_mask:0xf
    v_max_u32_dpp v40, v40, v40 row_mirror row_mask:0xf bank_mask:0xf
    v_med3_u32 v37, v36, v37, v84
    v_max_u32 v36, v36, v84
    v_med3_u32 v38, v37, v38, v85
    v_max_u32 v37, v37, v85
    v_min_u32_dpp v41, v41, v41 row_bcast:15 row_mask:0xa bank_mask:0xf
    v_max_u32_dpp v40, v40, v40 row_bcast:15 row_mask:0xa bank_mask:0xf
    v_med3_u32 v38, v37, v38, v88
    v_med3_u32 v37, v36, v37, v88
    v_max_u32 v36, v36, v88
    v_med3_u32 v38, v37, v38, v89
    v_min_u32_dpp v41, v41, v41 row_bcast:31 row_mask:0xc bank_mask:0xf
    v_max_u32_dpp v40, v40, v40 row_bcast:31 row_mask:0xc bank_mask:0xf
    v_max_u32 v37, v37, v89
    v_med3_u32 v38, v37, v38, v92
    v_readlane_b32 s6, v41, 63
    v_readlane_b32 s7, v40, 63
    v_med3_u32 v37, v36, v37, v92
    v_max_u32 v36, v36, v92
    v_med3_u32 v38, v37, v38, v93
    v_max_u32 v37, v37, v93
    v_max3_u32 v38, v38, v70, v74
    v_max3_u32 v38, v38, v78, v82
    v_max3_u32 v38, v38, v86, v90
    v_max_u32 v38, v38, v94
    s_barrier
    s_sub_u32 s14, s7, s6
    s_lshr_b32 s14, s14, 2
LA_bis:
    s_add_u32 s14, s14, s6
    v_cmp_le_u32 s[68:69], s14, v36
    v_cmp_le_u32 vcc, s14, v37
    s_bcnt1_i32_b64 s15, s[68:69]
    s_bcnt1_i32_b64 s67, vcc
    s_add_u32 s67, s67, s15
    s_cmp_eq_u32 s67, 8
    s_cbranch_scc1 LA_bis_done
    s_cmp_gt_u32 s67, 8
    s_cselect_b32 s6, s14, s6
    s_cselect_b32 s7, s7, s14
    s_sub_u32 s14, s7, s6
    s_lshr_b32 s14, s14, 1
    s_cbranch_scc1 LA_bis
    s_mov_b32 s14, s6
    v_cmp_le_u32 s[68:69], s14, v36
    v_cmp_le_u32 vcc, s14, v37
    s_bcnt1_i32_b64 s15, s[68:69]
LA_bis_done:
    v_cmp_le_u32 s[64:65], s14, v38
LA_pick:
    v_mbcnt_lo_u32_b32 v40, s68, 0
    v_mov_b32 v41, s15
    s_cmp_lg_u64 s[64:65], 0
    s_cbranch_scc1 LA_slow
    v_mbcnt_hi_u32_b32 v40, s69, v40
    v_mbcnt_lo_u32_b32 v41, vcc_lo, v41
    v_or_b32 v36, s71, v36
    v_mbcnt_hi_u32_b32 v41, vcc_hi, v41
    v_lshlrev_b32 v40, 2, v40
    v_or_b32 v37, s71, v37
    v_lshlrev_b32 v41, 2, v41
    v_and_b32 v40, 28, v40
    v_and_b32 v41, 28, v41
    s_mov_b64 exec, s[68:69]
    ds_write_b32 v40, v36 offset:128
    s_mov_b64 exec, vcc
    ds_write_b32 v41, v37 offset:128
    s_mov_b64 exec, -1
    ds_read_b32 v44, v52 offset:128
    ds_read_b32 v46, v52 offset:132
    v_lshlrev_b32 v2, 2, v9
    ds_read_b32 v54, v2 offset:128
    s_cmp_eq_u32 s71, 0
    s_waitcnt lgkmcnt(1)
    s_cbranch_scc1 LA_far
    global_store_dwordx4 v50, v[44:47], s[46:47] offset:0
    global_store_dwordx4 v50, v[44:47], s[46:47] offset:256
    s_mov_b32 exec_hi, 0xffff
    global_store_dwordx4 v51, v[44:47], s[46:47] offset:0
    global_store_dwordx4 v51, v[44:47], s[46:47] offset:256
    s_mov_b32 exec_hi, -1
LA_sent:
    v_lshrrev_b32 v12, 3, v1
    s_lshl_b32 s6, s63, 10
    v_lshl_add_u32 v12, v12, 7, s6
    s_waitcnt lgkmcnt(0)
    v_not_b32 v38, v54
    v_and_b32 v39, 2047, v38
    v_lshl_add_u32 v12, v39, 11, v12
    global_load_dword v13, v12, s[16:17]
    v_lshlrev_b32 v39, 2, v39
    ds_read_b32 v33, v39 offset:8192
    v_ashrrev_i32 v38, 31, v38
    v_or_b32 v38, 0x80000000, v38
    v_xor_b32 v32, v54, v38
    v_and_b32 v32, 0xffff0000, v32
    v_mul_f32 v32, 0xbfb8aa3b, v32
    v_exp_f32 v32, v32
    v_lshl_add_u32 v42, v1, 3, s70
    v_add_f32 v32, 1.0, v32
    v_rcp_f32 v32, v32
    s_waitcnt lgkmcnt(0)
    v_lshlrev_b32 v33, 16, v33
    v_sub_f32 v33, 1.0, v33
    v_cvt_pk_bf16_f32 v32, v32, v32
    v_lshlrev_b32 v32, 16, v32
    v_mul_f32 v48, v32, v33
    s_mov_b64 exec, 0xffff
    s_cmp_eq_u32 s71, 0
    s_cbranch_scc1 LA_far2
    global_store_dwordx2 v42, v[48:49], s[46:47] offset:128
LA_sent2:
    s_cmp_lg_u32 s2, 118
    s_cbranch_scc1 LA_watch
    v_lshlrev_b32 v42, 3, v1
    v_add_u32 v42, 131072, v42
    global_store_dwordx2 v42, v[54:55], s[46:47] sc1
    v_mov_b32 v43, 61440
    s_mov_b64 exec, 1
    global_store_dword v43, v47, s[46:47] sc1
LA_watch:
    s_mov_b64 exec, -1
    s_lshl_b32 s6, s4, 2
    s_lshr_b32 s6, 0x75643210, s6
    s_and_b32 s6, s6, 7
    s_lshl_b32 s6, s6, 10
    s_add_u32 s6, s6, 180224
    v_lshl_add_u32 v42, v9, 7, s6
    global_load_dword v13, v42, s[46:47] sc1
    s_mul_i32 s6, s101, 14
    s_add_u32 s6, s6, s63
    s_lshl_b32 s6, s6, 12
    s_add_u32 s6, s6, 1048576
    v_lshrrev_b32 v2, 3, v1
    v_min_u32 v43, 6, v2
    v_lshl_add_u32 v43, v43, 13, s6
    v_lshl_add_u32 v43, v9, 9, v43
    s_lshl_b32 s6, s63, 5
    s_add_u32 s6, s6, s4
    s_lshl_b32 s6, s6, 7
    s_add_u32 s6, s6, 180224
    v_lshl_add_u32 v42, v2, 10, s6
    v_lshl_add_u32 v42, v9, 4, v42
    v_mov_b32 v44, s60
    v_mov_b32 v46, s60
    s_mov_b32 s14, 0
LA_w:
    s_sleep 2
    global_load_ubyte v40, v43, s[46:47] sc1
    s_and_b32 s6, s60, 0xff
    s_add_u32 s14, s14, 1
    s_cmp_ge_u32 s14, 40000
    s_waitcnt vmcnt(0)
    v_cmp_ne_u32 vcc, s6, v40
    s_cbranch_scc1 LA_go
    s_cbranch_vccnz LA_w
LA_go:
    s_mov_b32 exec_hi, 0
    global_store_dwordx4 v42, v[44:47], s[46:47] sc1
LA_end:
    s_endpgm
LA_rest:
    s_waitcnt lgkmcnt(0)
    s_barrier
    s_branch LA_end
LA_far2:
    global_store_dwordx2 v42, v[48:49], s[46:47] offset:128 sc1
    s_branch LA_sent2
LA_far:
    global_store_dwordx4 v50, v[44:47], s[46:47] offset:0 sc1
    global_store_dwordx4 v50, v[44:47], s[46:47] offset:256 sc1
    s_mov_b32 exec_hi, 0xffff
    global_store_dwordx4 v51, v[44:47], s[46:47] offset:0 sc1
    global_store_dwordx4 v51, v[44:47], s[46:47] offset:256 sc1
    s_mov_b32 exec_hi, -1
    s_branch LA_sent
LA_slow:
    ds_read_b128 v[64:67], v3 offset:8192
    ds_read_b128 v[68:71], v3 offset:9216
    ds_read_b128 v[72:75], v3 offset:10240
    ds_read_b128 v[76:79], v3 offset:11264
    ds_read_b128 v[80:83], v3 offset:12288
    ds_read_b128 v[84:87], v3 offset:13312
    ds_read_b128 v[88:91], v3 offset:14336
    ds_read_b128 v[92:95], v3 offset:15360
    v_lshlrev_b32 v57, 2, v1
    v_sub_u32 v57, 2047, v57
    s_waitcnt lgkmcnt(0)
    v_subrev_u32 v58, 0, v57
    v_and_or_b32 v64, v64, s66, v58
    v_subrev_u32 v58, 1, v57
    v_and_or_b32 v65, v65, s66, v58
    v_subrev_u32 v58, 2, v57
    v_and_or_b32 v66, v66, s66, v58
    v_subrev_u32 v58, 3, v57
    v_and_or_b32 v67, v67, s66, v58
    v_subrev_u32 v58, 256, v57
    v_and_or_b32 v68, v68, s66, v58
    v_subrev_u32 v58, 257, v57
    v_and_or_b32 v69, v69, s66, v58
    v_subrev_u32 v58, 258, v57
    v_and_or_b32 v70, v70, s66, v58
    v_subrev_u32 v58, 259, v57
    v_and_or_b32 v71, v71, s66, v58
    v_subrev_u32 v58, 512, v57
    v_and_or_b32 v72, v72, s66, v58
    v_subrev_u32 v58, 513, v57
    v_and_or_b32 v73, v73, s66, v58
    v_subrev_u32 v58, 514, v57
    v_and_or_b32 v74, v74, s66, v58
    v_subrev_u32 v58, 515, v57
    v_and_or_b32 v75, v75, s66, v58
    v_subrev_u32 v58, 768, v57
    v_and_or_b32 v76, v76, s66, v58
    v_subrev_u32 v58, 769, v57
    v_and_or_b32 v77, v77, s66, v58
    v_subrev_u32 v58, 770, v57
    v_and_or_b32 v78, v78, s66, v58
    v_subrev_u32 v58, 771, v57
    v_and_or_b32 v79, v79, s66, v58
    v_subrev_u32 v58, 1024, v57
    v_and_or_b32 v80, v80, s66, v58
    v_subrev_u32 v58, 1025, v57
    v_and_or_b32 v81, v81, s66, v58
    v_subrev_u32 v58, 1026, v57
    v_and_or_b32 v82, v82, s66, v58
    v_subrev_u32 v58, 1027, v57
    v_and_or_b32 v83, v83, s66, v58
    v_subrev_u32 v58, 1280, v57
    v_and_or_b32 v84, v84, s66, v58
    v_subrev_u32 v58, 1281, v57
    v_and_or_b32 v85, v85, s66, v58
    v_subrev_u32 v58, 1282, v57
    v_and_or_b32 v86, v86, s66, v58
    v_subrev_u32 v58, 1283, v57
    v_and_or_b32 v87, v87, s66, v58
    v_subrev_u32 v58, 1536, v57
    v_and_or_b32 v88, v88, s66, v58
    v_subrev_u32 v58, 1537, v57
    v_and_or_b32 v89, v89, s66, v58
    v_subrev_u32 v58, 1538, v57
    v_and_or_b32 v90, v90, s66, v58
    v_subrev_u32 v58, 1539, v57
    v_and_or_b32 v91, v91, s66, v58
    v_subrev_u32 v58, 1792, v57
    v_and_or_b32 v92, v92, s66, v58
    v_subrev_u32 v58, 1793, v57
    v_and_or_b32 v93, v93, s66, v58
    v_subrev_u32 v58, 1794, v57
    v_and_or_b32 v94, v94, s66, v58
    v_subrev_u32 v58, 1795, v57
    v_and_or_b32 v95, v95, s66, v58
    s_mov_b32 s14, -1
    s_mov_b32 m0, 0
LA_slow_rnd:
    v_sub_u32 v57, s14, v64
    v_sub_u32 v58, s14, v65
    v_min_u32 v56, v57, v58
    v_sub_u32 v57, s14, v66
    v_sub_u32 v58, s14, v67
    v_min3_u32 v56, v57, v58, v56
    v_sub_u32 v57, s14, v68
    v_sub_u32 v58, s14, v69
    v_min3_u32 v56, v57, v58, v56
    v_sub_u32 v57, s14, v70
    v_sub_u32 v58, s14, v71
    v_min3_u32 v56, v57, v58, v56
    v_sub_u32 v57, s14, v72
    v_sub_u32 v58, s14, v73
    v_min3_u32 v56, v57, v58, v56
    v_sub_u32 v57, s14, v74
    v_sub_u32 v58, s14, v75
    v_min3_u32 v56, v57, v58, v56
    v_sub_u32 v57, s14, v76
    v_sub_u32 v58, s14, v77
    v_min3_u32 v56, v57, v58, v56
    v_sub_u32 v57, s14, v78
    v_sub_u32 v58, s14, v79
    v_min3_u32 v56, v57, v58, v56
    v_sub_u32 v57, s14, v80
    v_sub_u32 v58, s14, v81
    v_min3_u32 v56, v57, v58, v56
    v_sub_u32 v57, s14, v82
    v_sub_u32 v58, s14, v83
    v_min3_u32 v56, v57, v58, v56
    v_sub_u32 v57, s14, v84
    v_sub_u32 v58, s14, v85
    v_min3_u32 v56, v57, v58, v56
    v_sub_u32 v57, s14, v86
    v_sub_u32 v58, s14, v87
    v_min3_u32 v56, v57, v58, v56
    v_sub_u32 v57, s14, v88
    v_sub_u32 v58, s14, v89
    v_min3_u32 v56, v57, v58, v56
    v_sub_u32 v57, s14, v90
    v_sub_u32 v58, s14, v91
    v_min3_u32 v56, v57, v58, v56
    v_sub_u32 v57, s14, v92
    v_sub_u32 v58, s14, v93
    v_min3_u32 v56, v57, v58, v56
    v_sub_u32 v57, s14, v94
    v_sub_u32 v58, s14, v95
    v_min3_u32 v56, v57, v58, v56
    s_nop 1
    v_min_u32_dpp v56, v56, v56 row_shr:1 row_mask:0xf bank_mask:0xf
    s_nop 1
    v_min_u32_dpp v56, v56, v56 row_shr:2 row_mask:0xf bank_mask:0xf
    s_nop 1
    v_min_u32_dpp v56, v56, v56 row_shr:4 row_mask:0xf bank_mask:0xf
    s_nop 1
    v_min_u32_dpp v56, v56, v56 row_shr:8 row_mask:0xf bank_mask:0xf
    s_nop 1
    v_min_u32_dpp v56, v56, v56 row_bcast:15 row_mask:0xa bank_mask:0xf
    s_nop 1
    v_min_u32_dpp v56, v56, v56 row_bcast:31 row_mask:0xc bank_mask:0xf
    s_nop 0
    v_readlane_b32 s15, v56, 63
    s_sub_u32 s14, s14, s15
    v_writelane_b32 v36, s14, m0
    s_sub_u32 s14, s14, 1
    s_add_u32 m0, m0, 1
    s_cmp_lt_u32 m0, 8
    s_cbranch_scc1 LA_slow_rnd
    s_mov_b64 s[68:69], 0xff
    s_mov_b64 vcc, 0
    s_mov_b64 s[64:65], 0
    s_mov_b32 s15, 8
    s_branch LA_pick
L_end:
    s_endpgm
L_codeend:
.section .rodata,"a"
.p2align 6
.amdhsa_kernel gated_mix__ssm_conv_s4d__moe_arch_mod__prompt_kernel
  .amdhsa_next_free_vgpr 256
  .amdhsa_next_free_sgpr 102
  .amdhsa_accum_offset 256
  .amdhsa_group_segment_fixed_size 0
  .amdhsa_kernarg_size 128
  .amdhsa_user_sgpr_count 2
  .amdhsa_user_sgpr_kernarg_segment_ptr 1
  .amdhsa_system_sgpr_workgroup_id_x 1
.end_amdhsa_kernel
```
